```python
import torch

def _softmax(x, axis=-1):
    return torch.softmax(x, dim=axis)
def _gelu(x):
    return torch.nn.functional.gelu(x, approximate="tanh")
def _silu(x):
    return torch.nn.functional.silu(x)
def _sigmoid(x):
    return torch.sigmoid(x)
def _layernorm(x, axis=-1, eps=1e-5):
    m = x.mean(dim=axis, keepdim=True)
    v = x.var(dim=axis, keepdim=True, unbiased=False)
    return (x - m) / torch.sqrt(v + eps)
def _scatter_add(tgt, idx, src, axis=0):
    return tgt.clone().index_add_(axis, idx, src)
def _segment_sum(src, seg, n):
    out = torch.zeros((n,) + src.shape[1:], dtype=src.dtype)
    return out.index_add_(0, seg, src)
def _pad(x, pw):
    flat = tuple(v for pair in reversed(pw) for v in pair)
    return torch.nn.functional.pad(x, flat)

kernel_name = 'concat_heads__linear_kernel_hedgehog__ssm_conv_s4d__prompt'

def setup_inputs():

    _w = (lambda a: (lambda t: t.to(torch.bfloat16) if t.is_floating_point() else t)(torch.as_tensor(a)))
    def _A_setup():
        B, S, D, H = 1, 2048, 1024, 32
        Dh = D // H
        return {
            "x": _w((lambda *s: torch.randn(*s, dtype=torch.bfloat16) * 0.4)(B, S, D)),
            "wqkv": _w((lambda *s: torch.randn(*s, dtype=torch.bfloat16) * 0.4)(D, 3 * D)),
            "w_phi": _w((lambda *s: torch.randn(*s, dtype=torch.bfloat16) * 0.4)(H, Dh, Dh) * (Dh ** -0.5)),
            "wo": _w((lambda *s: torch.randn(*s, dtype=torch.bfloat16) * 0.05)(D, D)),
        }
    _A_in = _A_setup()

    def _B_setup():
        Bsz, L, D, N = 1, 2048, 1024, 128
        return {
            "u": _w((lambda *s: torch.randn(*s, dtype=torch.bfloat16) * 0.05)(Bsz, L, D)),
            "log_A_real": _w((lambda *s: torch.randn(*s, dtype=torch.bfloat16) * 3.2)(D, N) * 0.5),
            "A_imag": _w((lambda *s: torch.randn(*s, dtype=torch.bfloat16) * 0.2)(D, N) * 3.14),
            "C_real": _w((lambda *s: torch.randn(*s, dtype=torch.bfloat16) * 3.2)(D, N) / N ** 0.5),
            "C_imag": _w((lambda *s: torch.randn(*s, dtype=torch.bfloat16) * 3.2)(D, N) / N ** 0.5),
            "log_dt": _w((lambda *s: torch.randn(*s, dtype=torch.bfloat16) * 0.2)(D) * 0.5 - 4.0),
            "D_skip": _w((lambda *s: torch.randn(*s, dtype=torch.bfloat16) * 0.2)(D)),
        }
    _B_in = _B_setup()

    return {
        "A_x": _A_in["x"],
        "A_wqkv": _A_in["wqkv"],
        "A_w_phi": _A_in["w_phi"],
        "A_wo": _A_in["wo"],
        "B_u": _B_in["u"],
        "B_log_A_real": _B_in["log_A_real"],
        "B_A_imag": _B_in["A_imag"],
        "B_C_real": _B_in["C_real"],
        "B_C_imag": _B_in["C_imag"],
        "B_log_dt": _B_in["log_dt"],
        "B_D_skip": _B_in["D_skip"],
    }

def reference(A_x, A_wqkv, A_w_phi, A_wo, B_u, B_log_A_real, B_A_imag, B_C_real, B_C_imag, B_log_dt, B_D_skip):
    def _A_ref(x, wqkv, w_phi, wo):
        B, S, D = x.shape
        H = 32; Dh = D // H
        qkv = (lambda x, *d: x.permute(*d))((x @ wqkv).reshape(B, S, 3, H, Dh), 2, 0, 3, 1, 4)
        q, k, v = qkv[0], qkv[1], qkv[2]
        pq = torch.einsum("bhsd,hdf->bhsf", q, w_phi)
        pk = torch.einsum("bhsd,hdf->bhsf", k, w_phi)
        phi_q = torch.concatenate([_softmax(pq, axis=-1), _softmax(-pq, axis=-1)], axis=-1)
        phi_k = torch.concatenate([_softmax(pk, axis=-1), _softmax(-pk, axis=-1)], axis=-1)
        kv = torch.einsum("bhsf,bhsd->bhfd", phi_k, v)
        z  = torch.einsum("bhsf->bhf", phi_k)
        num = torch.einsum("bhqf,bhfd->bhqd", phi_q, kv)
        den = torch.einsum("bhqf,bhf->bhq", phi_q, z)[..., None] + 1e-6
        o = num / den
        return (lambda x, *d: x.permute(*d))(o, 0, 2, 1, 3).reshape(B, S, D) @ wo

    def _B_ref(u, log_A_real, A_imag, C_real, C_imag, log_dt, D_skip):
        L = u.shape[1]
        dt = torch.exp(log_dt)
        A = -torch.exp(log_A_real) + 1j * A_imag
        C = (C_real + 1j * C_imag) * dt[:, None]
        pos = (lambda x, dt: x.to(dt))(torch.arange(L), log_dt.dtype)
        P = torch.exp((A * dt[:, None])[:, :, None] * pos[None, None, :])
        K = 2.0 * torch.einsum("dn,dnl->dl", C, P).real
        L2 = 2 * L
        u_t = (lambda x, *d: x.permute(*d))(u, 0, 2, 1)
        Kf = (lambda x, *a, **k: torch.fft.rfft(x.float(), *a, **k))(K, L2)
        Uf = (lambda x, *a, **k: torch.fft.rfft(x.float(), *a, **k))(u_t, L2)
        y = (lambda x, *a, **k: torch.fft.irfft(x, *a, **k).to(torch.bfloat16))(Uf * Kf[None, :, :], L2)[:, :, :L]
        y = (lambda x, *d: x.permute(*d))(y, 0, 2, 1)
        return y + u * D_skip[None, None, :]

    a = _A_ref(A_x, A_wqkv, A_w_phi, A_wo)
    b = _B_ref(B_u, B_log_A_real, B_A_imag, B_C_real, B_C_imag, B_log_dt, B_D_skip)
    return torch.concatenate([a, b], axis=-1)
```

```asm
; @launch grid=(256,1,1) block=(512,1,1) lds=163840
.amdgcn_target "amdgcn-amd-amdhsa--gfx950"
.text
.globl concat_heads__linear_kernel_hedgehog__ssm_conv_s4d__prompt_kernel
.p2align 8
.type concat_heads__linear_kernel_hedgehog__ssm_conv_s4d__prompt_kernel,@function
concat_heads__linear_kernel_hedgehog__ssm_conv_s4d__prompt_kernel:
K_start:
    s_cmp_ge_u32 s2, 256
    s_cbranch_scc1 K_end
    s_load_dwordx4 s[4:7], s[0:1], 0
    s_load_dwordx16 s[80:95], s[0:1], 24
    s_load_dwordx2 s[36:37], s[0:1], 16
    s_load_dwordx2 s[50:51], s[0:1], 88
    s_load_dwordx4 s[52:55], s[0:1], 96
    s_memrealtime s[56:57]
    s_getpc_b64 s[62:63]
K_pc:
    s_bfe_u32 s60, s2, 0x20003
    v_lshrrev_b32 v3, 6, v0
    v_cmp_eq_u32 vcc, s60, v3
    v_lshlrev_b32 v3, 7, v0
    s_cbranch_vccz K_nocpf
    v_min_u32 v3, K_end-K_pc, v3
    global_load_dword v250, v3, s[62:63]
K_nocpf:
    v_lshrrev_b32 v2, 6, v0
    v_and_b32 v1, 63, v0
    v_readfirstlane_b32 s28, v2
    s_and_b32 s24, s2, 7
    s_lshr_b32 s25, s2, 3
    s_and_b32 s26, s24, 0
    s_lshl_b32 s26, s26, 4
    s_and_b32 s29, s25, 15
    s_add_u32 s26, s26, s29
    s_lshr_b32 s27, s24, 0
    s_lshl_b32 s27, s27, 1
    s_lshr_b32 s30, s25, 4
    s_add_u32 s27, s27, s30
    s_lshr_b32 s31, s28, 2
    s_and_b32 s28, s28, 3
    s_xor_b32 s35, s27, 1
    s_lshl_b32 s3, s27, 4
    s_add_u32 s3, s3, s26
    s_lshl_b32 s3, s3, 14
    s_lshl_b32 s66, s35, 4
    s_add_u32 s66, s66, s26
    s_lshl_b32 s67, s66, 2
    s_add_u32 s67, s67, s28
    s_lshl_b32 s32, s67, 8
    v_lshl_add_u32 v10, v1, 2, s32
    s_lshr_b32 s64, s67, 1
    s_lshl_b32 s64, s64, 2
    s_and_b32 s100, s24, 3
    s_lshl_b32 s100, s100, 1
    v_lshrrev_b32 v14, 3, v1
    v_and_b32 v15, 7, v1
    v_lshrrev_b32 v16, 4, v1
    v_xor_b32 v16, v15, v16
    v_lshlrev_b32 v16, 4, v16
    v_lshl_add_u32 v16, v14, 11, v16
    s_lshl_b32 s32, s26, 2
    s_add_u32 s32, s32, s28
    s_lshl_b32 s32, s32, 16
    v_add_u32 v2, s32, v16
    v_xor_b32 v16, 64, v2
    v_add_u32 v3, 15360, v16
    v_add_u32 v4, 30720, v2
    v_add_u32 v5, 46080, v16
    s_lshl_b32 s20, s28, 12
    v_lshlrev_b32 v16, 1, v14
    v_and_b32 v16, 4, v16
    v_xor_b32 v16, v15, v16
    s_and_b32 s32, s28, 1
    s_lshl_b32 s32, s32, 1
    v_xor_b32 v16, s32, v16
    v_lshlrev_b32 v16, 4, v16
    v_mul_u32_u24 v14, 6144, v14
    v_add_u32 v16, v14, v16
    s_mul_i32 s32, s28, 49152
    s_lshl_b32 s33, s27, 7
    s_add_u32 s32, s32, s33
    v_add_u32 v6, s32, v16
    v_add_u32 v7, 1024, v6
    v_add_u32 v8, 2048, v6
    s_mul_i32 s21, s28, 3072
    s_add_u32 s21, s21, 16384
    s_mov_b32 s19, 0
    s_bfe_u32 s32, s29, 65539
    s_mul_i32 s48, s32, 196608
    s_sub_u32 s39, 196608, s48
    s_mul_i32 s32, s32, 12288
    s_sub_u32 s38, s21, s32
    s_add_u32 s38, s38, 12288
    s_add_u32 s21, s21, s32
    s_xor_b32 s23, s30, s29
    s_and_b32 s23, s23, 7
    s_mov_b32 s22, 0
    s_waitcnt lgkmcnt(0)
    s_mov_b32 s8, s4
    s_mov_b32 s9, s5
    s_mov_b32 s10, 4194304
    s_mov_b32 s11, 0x20000
    s_mov_b32 s12, s6
    s_mov_b32 s13, s7
    s_mov_b32 s14, 6291456
    s_mov_b32 s15, 0x20000
    s_mov_b32 s19, 81920
    s_cmp_eq_u32 s31, 0
    s_cbranch_scc1 G_first
    s_setprio 3
    global_load_dword v236, v10, s[84:85]
    global_load_dword v237, v10, s[86:87]
    global_load_dword v238, v10, s[88:89]
    global_load_dword v239, v10, s[90:91]
    s_barrier
    s_load_dword s65, s[92:93], s64
    s_load_dword s75, s[94:95], s64
    s_add_u32 s32, s2, s28
    s_cmp_eq_u32 s32, 0
    s_cbranch_scc0 S_entry
    s_and_b32 s56, s56, -16
    s_or_b32 s57, s57, 0x40000000
    v_mov_b32 v16, s56
    v_mov_b32 v17, s57
    v_mov_b32 v18, 0
    s_mov_b64 exec, 1
    global_store_dwordx2 v18, v[16:17], s[52:53] sc1
    s_mov_b64 exec, -1
    s_branch S_entry
G_first:
    s_barrier
    s_and_b32 s16, s23, 3
    s_xor_b32 s17, s22, s16
    s_xor_b32 s17, s17, s100
    s_lshl_b32 s16, s17, 7
    s_mul_i32 s17, s17, 393216
    s_add_u32 m0, s19, s21
    s_add_u32 s18, s17, s39
    s_add_u32 s17, s17, s48
    buffer_load_dwordx4 v6, s[12:15], s17 offen offset:0 lds
    buffer_load_dwordx4 v7, s[12:15], s17 offen offset:1024 lds
    buffer_load_dwordx4 v8, s[12:15], s17 offen offset:2048 lds
    s_add_u32 m0, s19, s20
    s_add_u32 s22, s22, 1
    buffer_load_dwordx4 v2, s[8:11], s16 offen offset:0 lds
    buffer_load_dwordx4 v3, s[8:11], s16 offen offset:1024 lds
    buffer_load_dwordx4 v4, s[8:11], s16 offen offset:2048 lds
    buffer_load_dwordx4 v5, s[8:11], s16 offen offset:3072 lds
    s_add_u32 m0, s19, s38
    s_and_b32 s22, s22, 15
    buffer_load_dwordx4 v6, s[12:15], s18 offen offset:0 lds
    buffer_load_dwordx4 v7, s[12:15], s18 offen offset:1024 lds
    buffer_load_dwordx4 v8, s[12:15], s18 offen offset:2048 lds
    s_add_u32 s19, s19, 40960
    s_cmp_eq_u32 s19, 163840
    s_cselect_b32 s19, 40960, s19
    s_branch G_entry
S_entry:
    s_setprio 0
    s_and_b32 s16, s23, 3
    s_xor_b32 s17, s22, s16
    s_xor_b32 s17, s17, s100
    s_lshl_b32 s16, s17, 7
    s_mul_i32 s17, s17, 393216
    s_add_u32 m0, s19, s21
    s_add_u32 s18, s17, s39
    s_add_u32 s17, s17, s48
    s_add_u32 m0, s19, s20
    s_add_u32 s22, s22, 1
    s_add_u32 m0, s19, s38
    s_and_b32 s22, s22, 15
    s_add_u32 s19, s19, 40960
    s_cmp_eq_u32 s19, 163840
    s_cselect_b32 s19, 40960, s19
    s_and_b32 s16, s23, 3
    s_xor_b32 s17, s22, s16
    s_xor_b32 s17, s17, s100
    s_lshl_b32 s16, s17, 7
    s_mul_i32 s17, s17, 393216
    s_add_u32 m0, s19, s21
    s_add_u32 s18, s17, s39
    s_add_u32 s17, s17, s48
    s_add_u32 m0, s19, s20
    s_add_u32 s22, s22, 1
    s_lshl_b32 s68, s26, 2
    s_add_u32 s68, s68, s28
    s_mul_i32 s69, s28, 8704
    v_lshrrev_b32 v12, 3, v1
    v_and_b32 v13, 7, v1
    v_lshlrev_b32 v13, 4, v13
    v_lshl_add_u32 v12, v12, 11, v13
    v_lshlrev_b32 v15, 4, v1
    v_mov_b32 v9, 0
    v_and_b32 v14, 15, v1
    v_lshlrev_b32 v14, 3, v14
    s_mov_b32 s56, 1069066811
    s_mov_b32 s57, 0x32a57060
    s_and_b32 s70, s24, 3
    s_lshl_b32 s70, s70, 2
    s_and_b32 s72, s25, 3
    s_add_u32 s70, s70, s72
    s_lshr_b32 s71, s24, 2
    s_lshl_b32 s71, s71, 3
    s_lshr_b32 s32, s25, 2
    s_add_u32 s71, s71, s32
    s_add_u32 s72, s72, s32
    s_and_b32 s72, s72, 1
    s_lshl_b32 s72, s72, 2
    s_lshl_b32 s63, s27, 11
    s_add_u32 s63, s63, 17825792
    s_lshl_b32 s33, s26, 3
    s_add_u32 s62, s63, s33
    s_lshl_b32 s32, s28, 12
    s_add_u32 s32, s32, s3
    s_add_u32 s32, s32, 0
    v_lshl_add_u32 v230, v1, 7, s32
    v_and_b32 v16, 15, v1
    v_min_u32 v16, 11, v16
    v_lshl_add_u32 v16, v16, 7, s63
    s_lshl_b32 s32, s27, 2
    s_add_u32 s32, s32, s28
    s_lshl_b32 s32, s32, 4
    s_add_u32 s32, s32, s26
    s_lshl_b32 s32, s32, 7
    s_add_u32 s32, s32, 16777216
    v_mov_b32 v17, s32
    s_mov_b32 s60, 0
    s_mov_b32 s61, 0xffff
    v_cndmask_b32 v230, v230, v16, s[60:61]
    s_mov_b32 s61, 0xffff0000
    v_cndmask_b32 v230, v230, v17, s[60:61]
    s_lshl_b32 s32, s27, 8
    s_and_b32 s33, s28, 2
    s_lshl_b32 s33, s33, 6
    s_add_u32 s32, s32, s33
    s_add_u32 s32, s32, 17301504
    v_writelane_b32 v230, s32, 63
    s_mov_b32 s76, s82
    s_mov_b32 s77, s83
    s_mov_b32 s78, 4194304
    s_mov_b32 s79, 0x20000
    s_mov_b32 s40, s54
    s_mov_b32 s41, s55
    s_mov_b32 s42, 268435456
    s_mov_b32 s43, 0x20000
    s_mov_b32 s44, s80
    s_mov_b32 s45, s81
    s_mov_b32 s46, 2097152
    s_mov_b32 s47, 0x20000
    s_and_b32 s32, s28, 1
    s_lshl_b32 s32, s32, 4
    s_waitcnt lgkmcnt(0)
    s_lshr_b32 s65, s65, s32
    s_lshr_b32 s75, s75, s32
    s_lshl_b32 s65, s65, 16
    s_lshl_b32 s75, s75, 16
    v_mov_b32 v240, s65
    v_mov_b32 v241, s75
    v_mul_f32 v36, s56, v240
    v_fma_f32 v37, s56, v240, -v36
    v_fma_f32 v37, s57, v240, v37
    v_exp_f32 v36, v36
    v_mul_f32 v37, 0x3f317218, v37
    v_fma_f32 v36, v36, v37, v36
    v_cvt_pk_bf16_f32 v36, v36, v36
    v_lshlrev_b32 v34, 16, v36
    s_waitcnt vmcnt(0)
    v_lshlrev_b32 v232, 16, v236
    v_and_b32 v236, 0xffff0000, v236
    v_lshlrev_b32 v233, 16, v237
    v_and_b32 v237, 0xffff0000, v237
    v_lshlrev_b32 v234, 16, v238
    v_and_b32 v238, 0xffff0000, v238
    v_lshlrev_b32 v235, 16, v239
    v_and_b32 v239, 0xffff0000, v239
    v_mul_f32 v36, s56, v232
    v_fma_f32 v37, s56, v232, -v36
    v_fma_f32 v37, s57, v232, v37
    v_exp_f32 v36, v36
    v_mul_f32 v37, 0x3f317218, v37
    v_fma_f32 v36, v36, v37, v36
    v_cvt_pk_bf16_f32 v36, v36, v36
    v_lshlrev_b32 v40, 16, v36
    v_mul_f32 v40, v40, v34
    v_mul_f32 v41, v233, v34
    v_mul_f32 v40, 0xbfb8aa3b, v40
    v_mul_f32 v41, 1042479491, v41
    v_add_f32 v36, v34, v34
    v_mul_f32 v44, v234, v36
    v_mul_f32 v45, v235, v36
    v_mul_f32 v88, 0x41000000, v41
    v_mul_f32 v90, 1.0, v41
    v_mul_f32 v92, 0x43800000, v41
    v_mul_f32 v94, 0x42000000, v41
    v_mul_f32 v89, 0x41000000, v40
    v_mul_f32 v91, 1.0, v40
    v_mul_f32 v93, 0x43800000, v40
    v_mul_f32 v95, 0x42000000, v40
    v_fract_f32 v88, v88
    v_fract_f32 v90, v90
    v_fract_f32 v92, v92
    v_fract_f32 v94, v94
    v_exp_f32 v89, v89
    v_exp_f32 v91, v91
    v_exp_f32 v93, v93
    v_exp_f32 v95, v95
    v_cos_f32 v52, v88
    v_cos_f32 v54, v90
    v_cos_f32 v56, v92
    v_cos_f32 v58, v94
    v_sin_f32 v53, v88
    v_sin_f32 v55, v90
    v_sin_f32 v57, v92
    v_sin_f32 v59, v94
    v_mul_f32 v52, v52, v89
    v_mul_f32 v54, v54, v91
    v_mul_f32 v56, v56, v93
    v_mul_f32 v58, v58, v95
    v_mul_f32 v53, v53, v89
    v_mul_f32 v55, v55, v91
    v_mul_f32 v57, v57, v93
    v_mul_f32 v59, v59, v95
    v_cvt_pk_bf16_f32 v112, v54, -v55
    v_cvt_pk_bf16_f32 v119, v56, -v57
    v_cvt_pk_bf16_f32 v138, v44, v45
    v_pk_mul_f32 v[88:89], v[54:55], v[54:55] op_sel:[1,1] op_sel_hi:[1,0] neg_lo:[1,0]
    v_pk_mul_f32 v[92:93], v[56:57], v[56:57] op_sel:[1,1] op_sel_hi:[1,0] neg_lo:[1,0]
    v_pk_mul_f32 v[96:97], v[44:45], v[52:53] op_sel:[1,1] op_sel_hi:[1,0] neg_lo:[1,0]
    v_pk_fma_f32 v[60:61], v[54:55], v[54:55], v[88:89] op_sel:[0,0,0] op_sel_hi:[0,1,1]
    v_pk_fma_f32 v[68:69], v[56:57], v[56:57], v[92:93] op_sel:[0,0,0] op_sel_hi:[0,1,1]
    v_pk_fma_f32 v[46:47], v[44:45], v[52:53], v[96:97] op_sel:[0,0,0] op_sel_hi:[0,1,1]
    v_cvt_pk_bf16_f32 v113, v60, -v61
    v_cvt_pk_bf16_f32 v124, v68, -v69
    v_cvt_pk_bf16_f32 v139, v46, v47
    v_pk_mul_f32 v[88:89], v[60:61], v[60:61] op_sel:[1,1] op_sel_hi:[1,0] neg_lo:[1,0]
    v_pk_mul_f32 v[92:93], v[68:69], v[56:57] op_sel:[1,1] op_sel_hi:[1,0] neg_lo:[1,0]
    v_pk_mul_f32 v[96:97], v[46:47], v[52:53] op_sel:[1,1] op_sel_hi:[1,0] neg_lo:[1,0]
    v_pk_fma_f32 v[62:63], v[60:61], v[60:61], v[88:89] op_sel:[0,0,0] op_sel_hi:[0,1,1]
    v_pk_fma_f32 v[70:71], v[68:69], v[56:57], v[92:93] op_sel:[0,0,0] op_sel_hi:[0,1,1]
    v_pk_fma_f32 v[48:49], v[46:47], v[52:53], v[96:97] op_sel:[0,0,0] op_sel_hi:[0,1,1]
    v_cvt_pk_bf16_f32 v115, v62, -v63
    v_cvt_pk_bf16_f32 v127, v70, -v71
    v_cvt_pk_bf16_f32 v140, v48, v49
    v_pk_mul_f32 v[88:89], v[60:61], v[54:55] op_sel:[1,1] op_sel_hi:[1,0] neg_lo:[1,0]
    v_pk_mul_f32 v[92:93], v[68:69], v[68:69] op_sel:[1,1] op_sel_hi:[1,0] neg_lo:[1,0]
    v_pk_mul_f32 v[96:97], v[48:49], v[52:53] op_sel:[1,1] op_sel_hi:[1,0] neg_lo:[1,0]
    v_pk_fma_f32 v[64:65], v[60:61], v[54:55], v[88:89] op_sel:[0,0,0] op_sel_hi:[0,1,1]
    v_pk_fma_f32 v[72:73], v[68:69], v[68:69], v[92:93] op_sel:[0,0,0] op_sel_hi:[0,1,1]
    v_pk_fma_f32 v[50:51], v[48:49], v[52:53], v[96:97] op_sel:[0,0,0] op_sel_hi:[0,1,1]
    v_cvt_pk_bf16_f32 v114, v64, -v65
    v_cvt_pk_bf16_f32 v130, v72, -v73
    v_cvt_pk_bf16_f32 v141, v50, v51
    v_pk_mul_f32 v[88:89], v[62:63], v[60:61] op_sel:[1,1] op_sel_hi:[1,0] neg_lo:[1,0]
    v_pk_mul_f32 v[92:93], v[56:57], v[52:53] op_sel:[1,1] op_sel_hi:[1,0] neg_lo:[1,0]
    v_pk_fma_f32 v[66:67], v[62:63], v[60:61], v[88:89] op_sel:[0,0,0] op_sel_hi:[0,1,1]
    v_pk_fma_f32 v[94:95], v[56:57], v[52:53], v[92:93] op_sel:[0,0,0] op_sel_hi:[0,1,1]
    v_cvt_pk_bf16_f32 v117, v66, -v67
    v_cvt_pk_bf16_f32 v123, v94, -v95
    v_pk_mul_f32 v[88:89], v[62:63], v[54:55] op_sel:[1,1] op_sel_hi:[1,0] neg_lo:[1,0]
    v_pk_mul_f32 v[92:93], v[72:73], v[56:57] op_sel:[1,1] op_sel_hi:[1,0] neg_lo:[1,0]
    v_pk_mul_f32 v[96:97], v[56:57], v[66:67] op_sel:[1,1] op_sel_hi:[1,0] neg_lo:[1,0]
    v_pk_fma_f32 v[90:91], v[62:63], v[54:55], v[88:89] op_sel:[0,0,0] op_sel_hi:[0,1,1]
    v_pk_fma_f32 v[74:75], v[72:73], v[56:57], v[92:93] op_sel:[0,0,0] op_sel_hi:[0,1,1]
    v_pk_fma_f32 v[98:99], v[56:57], v[66:67], v[96:97] op_sel:[0,0,0] op_sel_hi:[0,1,1]
    v_cvt_pk_bf16_f32 v116, v90, -v91
    v_cvt_pk_bf16_f32 v132, v74, -v75
    v_cvt_pk_bf16_f32 v122, v98, -v99
    v_pk_mul_f32 v[88:89], v[62:63], v[64:65] op_sel:[1,1] op_sel_hi:[1,0] neg_lo:[1,0]
    v_pk_mul_f32 v[92:93], v[72:73], v[68:69] op_sel:[1,1] op_sel_hi:[1,0] neg_lo:[1,0]
    v_pk_mul_f32 v[96:97], v[68:69], v[62:63] op_sel:[1,1] op_sel_hi:[1,0] neg_lo:[1,0]
    v_pk_fma_f32 v[90:91], v[62:63], v[64:65], v[88:89] op_sel:[0,0,0] op_sel_hi:[0,1,1]
    v_pk_fma_f32 v[76:77], v[72:73], v[68:69], v[92:93] op_sel:[0,0,0] op_sel_hi:[0,1,1]
    v_pk_fma_f32 v[98:99], v[68:69], v[62:63], v[96:97] op_sel:[0,0,0] op_sel_hi:[0,1,1]
    v_cvt_pk_bf16_f32 v118, v90, -v91
    v_cvt_pk_bf16_f32 v134, v76, -v77
    v_cvt_pk_bf16_f32 v125, v98, -v99
    v_pk_mul_f32 v[88:89], v[56:57], v[60:61] op_sel:[1,1] op_sel_hi:[1,0] neg_lo:[1,0]
    v_pk_mul_f32 v[92:93], v[72:73], v[70:71] op_sel:[1,1] op_sel_hi:[1,0] neg_lo:[1,0]
    v_pk_mul_f32 v[96:97], v[70:71], v[62:63] op_sel:[1,1] op_sel_hi:[1,0] neg_lo:[1,0]
    v_pk_fma_f32 v[90:91], v[56:57], v[60:61], v[88:89] op_sel:[0,0,0] op_sel_hi:[0,1,1]
    v_pk_fma_f32 v[78:79], v[72:73], v[70:71], v[92:93] op_sel:[0,0,0] op_sel_hi:[0,1,1]
    v_pk_fma_f32 v[98:99], v[70:71], v[62:63], v[96:97] op_sel:[0,0,0] op_sel_hi:[0,1,1]
    v_cvt_pk_bf16_f32 v120, v90, -v91
    v_cvt_pk_bf16_f32 v136, v78, -v79
    v_cvt_pk_bf16_f32 v128, v98, -v99
    v_pk_mul_f32 v[88:89], v[56:57], v[62:63] op_sel:[1,1] op_sel_hi:[1,0] neg_lo:[1,0]
    v_pk_mul_f32 v[92:93], v[70:71], v[52:53] op_sel:[1,1] op_sel_hi:[1,0] neg_lo:[1,0]
    v_pk_mul_f32 v[96:97], v[68:69], v[52:53] op_sel:[1,1] op_sel_hi:[1,0] neg_lo:[1,0]
    v_pk_fma_f32 v[90:91], v[56:57], v[62:63], v[88:89] op_sel:[0,0,0] op_sel_hi:[0,1,1]
    v_pk_fma_f32 v[94:95], v[70:71], v[52:53], v[92:93] op_sel:[0,0,0] op_sel_hi:[0,1,1]
    v_pk_fma_f32 v[98:99], v[68:69], v[52:53], v[96:97] op_sel:[0,0,0] op_sel_hi:[0,1,1]
    v_cvt_pk_bf16_f32 v121, v90, -v91
    v_cvt_pk_bf16_f32 v129, v94, -v95
    v_cvt_pk_bf16_f32 v126, v98, -v99
    v_pk_mul_f32 v[88:89], v[72:73], v[52:53] op_sel:[1,1] op_sel_hi:[1,0] neg_lo:[1,0]
    v_pk_mul_f32 v[92:93], v[74:75], v[52:53] op_sel:[1,1] op_sel_hi:[1,0] neg_lo:[1,0]
    v_pk_mul_f32 v[96:97], v[76:77], v[52:53] op_sel:[1,1] op_sel_hi:[1,0] neg_lo:[1,0]
    v_pk_mul_f32 v[100:101], v[78:79], v[52:53] op_sel:[1,1] op_sel_hi:[1,0] neg_lo:[1,0]
    v_pk_fma_f32 v[90:91], v[72:73], v[52:53], v[88:89] op_sel:[0,0,0] op_sel_hi:[0,1,1]
    v_pk_fma_f32 v[94:95], v[74:75], v[52:53], v[92:93] op_sel:[0,0,0] op_sel_hi:[0,1,1]
    v_pk_fma_f32 v[98:99], v[76:77], v[52:53], v[96:97] op_sel:[0,0,0] op_sel_hi:[0,1,1]
    v_pk_fma_f32 v[102:103], v[78:79], v[52:53], v[100:101] op_sel:[0,0,0] op_sel_hi:[0,1,1]
    v_cvt_pk_bf16_f32 v131, v90, -v91
    v_cvt_pk_bf16_f32 v133, v94, -v95
    v_cvt_pk_bf16_f32 v135, v98, -v99
    v_cvt_pk_bf16_f32 v137, v102, -v103
    v_pk_mul_f32 v[88:89], v[44:45], v[58:59] op_sel:[1,1] op_sel_hi:[1,0] neg_lo:[1,0]
    v_pk_mul_f32 v[90:91], v[46:47], v[58:59] op_sel:[1,1] op_sel_hi:[1,0] neg_lo:[1,0]
    v_pk_mul_f32 v[92:93], v[48:49], v[58:59] op_sel:[1,1] op_sel_hi:[1,0] neg_lo:[1,0]
    v_pk_mul_f32 v[94:95], v[50:51], v[58:59] op_sel:[1,1] op_sel_hi:[1,0] neg_lo:[1,0]
    v_pk_fma_f32 v[44:45], v[44:45], v[58:59], v[88:89] op_sel:[0,0,0] op_sel_hi:[0,1,1]
    v_pk_fma_f32 v[46:47], v[46:47], v[58:59], v[90:91] op_sel:[0,0,0] op_sel_hi:[0,1,1]
    v_pk_fma_f32 v[48:49], v[48:49], v[58:59], v[92:93] op_sel:[0,0,0] op_sel_hi:[0,1,1]
    v_pk_fma_f32 v[50:51], v[50:51], v[58:59], v[94:95] op_sel:[0,0,0] op_sel_hi:[0,1,1]
    v_cvt_pk_bf16_f32 v142, v44, v45
    v_cvt_pk_bf16_f32 v143, v46, v47
    v_cvt_pk_bf16_f32 v144, v48, v49
    v_cvt_pk_bf16_f32 v145, v50, v51
    v_pk_mul_f32 v[88:89], v[44:45], v[58:59] op_sel:[1,1] op_sel_hi:[1,0] neg_lo:[1,0]
    v_pk_mul_f32 v[90:91], v[46:47], v[58:59] op_sel:[1,1] op_sel_hi:[1,0] neg_lo:[1,0]
    v_pk_mul_f32 v[92:93], v[48:49], v[58:59] op_sel:[1,1] op_sel_hi:[1,0] neg_lo:[1,0]
    v_pk_mul_f32 v[94:95], v[50:51], v[58:59] op_sel:[1,1] op_sel_hi:[1,0] neg_lo:[1,0]
    v_pk_fma_f32 v[44:45], v[44:45], v[58:59], v[88:89] op_sel:[0,0,0] op_sel_hi:[0,1,1]
    v_pk_fma_f32 v[46:47], v[46:47], v[58:59], v[90:91] op_sel:[0,0,0] op_sel_hi:[0,1,1]
    v_pk_fma_f32 v[48:49], v[48:49], v[58:59], v[92:93] op_sel:[0,0,0] op_sel_hi:[0,1,1]
    v_pk_fma_f32 v[50:51], v[50:51], v[58:59], v[94:95] op_sel:[0,0,0] op_sel_hi:[0,1,1]
    v_cvt_pk_bf16_f32 v146, v44, v45
    v_cvt_pk_bf16_f32 v147, v46, v47
    v_cvt_pk_bf16_f32 v148, v48, v49
    v_cvt_pk_bf16_f32 v149, v50, v51
    v_pk_mul_f32 v[88:89], v[44:45], v[58:59] op_sel:[1,1] op_sel_hi:[1,0] neg_lo:[1,0]
    v_pk_mul_f32 v[90:91], v[46:47], v[58:59] op_sel:[1,1] op_sel_hi:[1,0] neg_lo:[1,0]
    v_pk_mul_f32 v[92:93], v[48:49], v[58:59] op_sel:[1,1] op_sel_hi:[1,0] neg_lo:[1,0]
    v_pk_mul_f32 v[94:95], v[50:51], v[58:59] op_sel:[1,1] op_sel_hi:[1,0] neg_lo:[1,0]
    v_pk_fma_f32 v[44:45], v[44:45], v[58:59], v[88:89] op_sel:[0,0,0] op_sel_hi:[0,1,1]
    v_pk_fma_f32 v[46:47], v[46:47], v[58:59], v[90:91] op_sel:[0,0,0] op_sel_hi:[0,1,1]
    v_pk_fma_f32 v[48:49], v[48:49], v[58:59], v[92:93] op_sel:[0,0,0] op_sel_hi:[0,1,1]
    v_pk_fma_f32 v[50:51], v[50:51], v[58:59], v[94:95] op_sel:[0,0,0] op_sel_hi:[0,1,1]
    v_cvt_pk_bf16_f32 v150, v44, v45
    v_cvt_pk_bf16_f32 v151, v46, v47
    v_cvt_pk_bf16_f32 v152, v48, v49
    v_cvt_pk_bf16_f32 v153, v50, v51
    v_pk_mul_f32 v[88:89], v[44:45], v[58:59] op_sel:[1,1] op_sel_hi:[1,0] neg_lo:[1,0]
    v_pk_mul_f32 v[90:91], v[46:47], v[58:59] op_sel:[1,1] op_sel_hi:[1,0] neg_lo:[1,0]
    v_pk_mul_f32 v[92:93], v[48:49], v[58:59] op_sel:[1,1] op_sel_hi:[1,0] neg_lo:[1,0]
    v_pk_mul_f32 v[94:95], v[50:51], v[58:59] op_sel:[1,1] op_sel_hi:[1,0] neg_lo:[1,0]
    v_pk_fma_f32 v[44:45], v[44:45], v[58:59], v[88:89] op_sel:[0,0,0] op_sel_hi:[0,1,1]
    v_pk_fma_f32 v[46:47], v[46:47], v[58:59], v[90:91] op_sel:[0,0,0] op_sel_hi:[0,1,1]
    v_pk_fma_f32 v[48:49], v[48:49], v[58:59], v[92:93] op_sel:[0,0,0] op_sel_hi:[0,1,1]
    v_pk_fma_f32 v[50:51], v[50:51], v[58:59], v[94:95] op_sel:[0,0,0] op_sel_hi:[0,1,1]
    v_cvt_pk_bf16_f32 v154, v44, v45
    v_cvt_pk_bf16_f32 v155, v46, v47
    v_cvt_pk_bf16_f32 v156, v48, v49
    v_cvt_pk_bf16_f32 v157, v50, v51
    v_pk_mul_f32 v[88:89], v[44:45], v[58:59] op_sel:[1,1] op_sel_hi:[1,0] neg_lo:[1,0]
    v_pk_mul_f32 v[90:91], v[46:47], v[58:59] op_sel:[1,1] op_sel_hi:[1,0] neg_lo:[1,0]
    v_pk_mul_f32 v[92:93], v[48:49], v[58:59] op_sel:[1,1] op_sel_hi:[1,0] neg_lo:[1,0]
    v_pk_mul_f32 v[94:95], v[50:51], v[58:59] op_sel:[1,1] op_sel_hi:[1,0] neg_lo:[1,0]
    v_pk_fma_f32 v[44:45], v[44:45], v[58:59], v[88:89] op_sel:[0,0,0] op_sel_hi:[0,1,1]
    v_pk_fma_f32 v[46:47], v[46:47], v[58:59], v[90:91] op_sel:[0,0,0] op_sel_hi:[0,1,1]
    v_pk_fma_f32 v[48:49], v[48:49], v[58:59], v[92:93] op_sel:[0,0,0] op_sel_hi:[0,1,1]
    v_pk_fma_f32 v[50:51], v[50:51], v[58:59], v[94:95] op_sel:[0,0,0] op_sel_hi:[0,1,1]
    v_cvt_pk_bf16_f32 v158, v44, v45
    v_cvt_pk_bf16_f32 v159, v46, v47
    v_cvt_pk_bf16_f32 v160, v48, v49
    v_cvt_pk_bf16_f32 v161, v50, v51
    v_pk_mul_f32 v[88:89], v[44:45], v[58:59] op_sel:[1,1] op_sel_hi:[1,0] neg_lo:[1,0]
    v_pk_mul_f32 v[90:91], v[46:47], v[58:59] op_sel:[1,1] op_sel_hi:[1,0] neg_lo:[1,0]
    v_pk_mul_f32 v[92:93], v[48:49], v[58:59] op_sel:[1,1] op_sel_hi:[1,0] neg_lo:[1,0]
    v_pk_mul_f32 v[94:95], v[50:51], v[58:59] op_sel:[1,1] op_sel_hi:[1,0] neg_lo:[1,0]
    v_pk_fma_f32 v[44:45], v[44:45], v[58:59], v[88:89] op_sel:[0,0,0] op_sel_hi:[0,1,1]
    v_pk_fma_f32 v[46:47], v[46:47], v[58:59], v[90:91] op_sel:[0,0,0] op_sel_hi:[0,1,1]
    v_pk_fma_f32 v[48:49], v[48:49], v[58:59], v[92:93] op_sel:[0,0,0] op_sel_hi:[0,1,1]
    v_pk_fma_f32 v[50:51], v[50:51], v[58:59], v[94:95] op_sel:[0,0,0] op_sel_hi:[0,1,1]
    v_cvt_pk_bf16_f32 v162, v44, v45
    v_cvt_pk_bf16_f32 v163, v46, v47
    v_cvt_pk_bf16_f32 v164, v48, v49
    v_cvt_pk_bf16_f32 v165, v50, v51
    v_pk_mul_f32 v[88:89], v[44:45], v[58:59] op_sel:[1,1] op_sel_hi:[1,0] neg_lo:[1,0]
    v_pk_mul_f32 v[90:91], v[46:47], v[58:59] op_sel:[1,1] op_sel_hi:[1,0] neg_lo:[1,0]
    v_pk_mul_f32 v[92:93], v[48:49], v[58:59] op_sel:[1,1] op_sel_hi:[1,0] neg_lo:[1,0]
    v_pk_mul_f32 v[94:95], v[50:51], v[58:59] op_sel:[1,1] op_sel_hi:[1,0] neg_lo:[1,0]
    v_pk_fma_f32 v[44:45], v[44:45], v[58:59], v[88:89] op_sel:[0,0,0] op_sel_hi:[0,1,1]
    v_pk_fma_f32 v[46:47], v[46:47], v[58:59], v[90:91] op_sel:[0,0,0] op_sel_hi:[0,1,1]
    v_pk_fma_f32 v[48:49], v[48:49], v[58:59], v[92:93] op_sel:[0,0,0] op_sel_hi:[0,1,1]
    v_pk_fma_f32 v[50:51], v[50:51], v[58:59], v[94:95] op_sel:[0,0,0] op_sel_hi:[0,1,1]
    v_cvt_pk_bf16_f32 v166, v44, v45
    v_cvt_pk_bf16_f32 v167, v46, v47
    v_cvt_pk_bf16_f32 v168, v48, v49
    v_cvt_pk_bf16_f32 v169, v50, v51
    v_mul_f32 v36, s56, v236
    v_fma_f32 v37, s56, v236, -v36
    v_fma_f32 v37, s57, v236, v37
    v_exp_f32 v36, v36
    v_mul_f32 v37, 0x3f317218, v37
    v_fma_f32 v36, v36, v37, v36
    v_cvt_pk_bf16_f32 v36, v36, v36
    v_lshlrev_b32 v40, 16, v36
    v_mul_f32 v40, v40, v34
    v_mul_f32 v41, v237, v34
    v_mul_f32 v40, 0xbfb8aa3b, v40
    v_mul_f32 v41, 1042479491, v41
    v_add_f32 v36, v34, v34
    v_mul_f32 v44, v238, v36
    v_mul_f32 v45, v239, v36
    v_mul_f32 v88, 0x41000000, v41
    v_mul_f32 v90, 1.0, v41
    v_mul_f32 v92, 0x43800000, v41
    v_mul_f32 v94, 0x42000000, v41
    v_mul_f32 v89, 0x41000000, v40
    v_mul_f32 v91, 1.0, v40
    v_mul_f32 v93, 0x43800000, v40
    v_mul_f32 v95, 0x42000000, v40
    v_fract_f32 v88, v88
    v_fract_f32 v90, v90
    v_fract_f32 v92, v92
    v_fract_f32 v94, v94
    v_exp_f32 v89, v89
    v_exp_f32 v91, v91
    v_exp_f32 v93, v93
    v_exp_f32 v95, v95
    v_cos_f32 v52, v88
    v_cos_f32 v54, v90
    v_cos_f32 v56, v92
    v_cos_f32 v58, v94
    v_sin_f32 v53, v88
    v_sin_f32 v55, v90
    v_sin_f32 v57, v92
    v_sin_f32 v59, v94
    v_mul_f32 v52, v52, v89
    v_mul_f32 v54, v54, v91
    v_mul_f32 v56, v56, v93
    v_mul_f32 v58, v58, v95
    v_mul_f32 v53, v53, v89
    v_mul_f32 v55, v55, v91
    v_mul_f32 v57, v57, v93
    v_mul_f32 v59, v59, v95
    v_cvt_pk_bf16_f32 v170, v54, -v55
    v_cvt_pk_bf16_f32 v177, v56, -v57
    v_cvt_pk_bf16_f32 v196, v44, v45
    v_pk_mul_f32 v[88:89], v[54:55], v[54:55] op_sel:[1,1] op_sel_hi:[1,0] neg_lo:[1,0]
    v_pk_mul_f32 v[92:93], v[56:57], v[56:57] op_sel:[1,1] op_sel_hi:[1,0] neg_lo:[1,0]
    v_pk_mul_f32 v[96:97], v[44:45], v[52:53] op_sel:[1,1] op_sel_hi:[1,0] neg_lo:[1,0]
    v_pk_fma_f32 v[60:61], v[54:55], v[54:55], v[88:89] op_sel:[0,0,0] op_sel_hi:[0,1,1]
    v_pk_fma_f32 v[68:69], v[56:57], v[56:57], v[92:93] op_sel:[0,0,0] op_sel_hi:[0,1,1]
    v_pk_fma_f32 v[46:47], v[44:45], v[52:53], v[96:97] op_sel:[0,0,0] op_sel_hi:[0,1,1]
    v_cvt_pk_bf16_f32 v171, v60, -v61
    v_cvt_pk_bf16_f32 v182, v68, -v69
    v_cvt_pk_bf16_f32 v197, v46, v47
    v_pk_mul_f32 v[88:89], v[60:61], v[60:61] op_sel:[1,1] op_sel_hi:[1,0] neg_lo:[1,0]
    v_pk_mul_f32 v[92:93], v[68:69], v[56:57] op_sel:[1,1] op_sel_hi:[1,0] neg_lo:[1,0]
    v_pk_mul_f32 v[96:97], v[46:47], v[52:53] op_sel:[1,1] op_sel_hi:[1,0] neg_lo:[1,0]
    v_pk_fma_f32 v[62:63], v[60:61], v[60:61], v[88:89] op_sel:[0,0,0] op_sel_hi:[0,1,1]
    v_pk_fma_f32 v[70:71], v[68:69], v[56:57], v[92:93] op_sel:[0,0,0] op_sel_hi:[0,1,1]
    v_pk_fma_f32 v[48:49], v[46:47], v[52:53], v[96:97] op_sel:[0,0,0] op_sel_hi:[0,1,1]
    v_cvt_pk_bf16_f32 v173, v62, -v63
    v_cvt_pk_bf16_f32 v185, v70, -v71
    v_cvt_pk_bf16_f32 v198, v48, v49
    v_pk_mul_f32 v[88:89], v[60:61], v[54:55] op_sel:[1,1] op_sel_hi:[1,0] neg_lo:[1,0]
    v_pk_mul_f32 v[92:93], v[68:69], v[68:69] op_sel:[1,1] op_sel_hi:[1,0] neg_lo:[1,0]
    v_pk_mul_f32 v[96:97], v[48:49], v[52:53] op_sel:[1,1] op_sel_hi:[1,0] neg_lo:[1,0]
    v_pk_fma_f32 v[64:65], v[60:61], v[54:55], v[88:89] op_sel:[0,0,0] op_sel_hi:[0,1,1]
    v_pk_fma_f32 v[72:73], v[68:69], v[68:69], v[92:93] op_sel:[0,0,0] op_sel_hi:[0,1,1]
    v_pk_fma_f32 v[50:51], v[48:49], v[52:53], v[96:97] op_sel:[0,0,0] op_sel_hi:[0,1,1]
    v_cvt_pk_bf16_f32 v172, v64, -v65
    v_cvt_pk_bf16_f32 v188, v72, -v73
    v_cvt_pk_bf16_f32 v199, v50, v51
    v_pk_mul_f32 v[88:89], v[62:63], v[60:61] op_sel:[1,1] op_sel_hi:[1,0] neg_lo:[1,0]
    v_pk_mul_f32 v[92:93], v[56:57], v[52:53] op_sel:[1,1] op_sel_hi:[1,0] neg_lo:[1,0]
    v_pk_fma_f32 v[66:67], v[62:63], v[60:61], v[88:89] op_sel:[0,0,0] op_sel_hi:[0,1,1]
    v_pk_fma_f32 v[94:95], v[56:57], v[52:53], v[92:93] op_sel:[0,0,0] op_sel_hi:[0,1,1]
    v_cvt_pk_bf16_f32 v175, v66, -v67
    v_cvt_pk_bf16_f32 v181, v94, -v95
    v_pk_mul_f32 v[88:89], v[62:63], v[54:55] op_sel:[1,1] op_sel_hi:[1,0] neg_lo:[1,0]
    v_pk_mul_f32 v[92:93], v[72:73], v[56:57] op_sel:[1,1] op_sel_hi:[1,0] neg_lo:[1,0]
    v_pk_mul_f32 v[96:97], v[56:57], v[66:67] op_sel:[1,1] op_sel_hi:[1,0] neg_lo:[1,0]
    v_pk_fma_f32 v[90:91], v[62:63], v[54:55], v[88:89] op_sel:[0,0,0] op_sel_hi:[0,1,1]
    v_pk_fma_f32 v[74:75], v[72:73], v[56:57], v[92:93] op_sel:[0,0,0] op_sel_hi:[0,1,1]
    v_pk_fma_f32 v[98:99], v[56:57], v[66:67], v[96:97] op_sel:[0,0,0] op_sel_hi:[0,1,1]
    v_cvt_pk_bf16_f32 v174, v90, -v91
    v_cvt_pk_bf16_f32 v190, v74, -v75
    v_cvt_pk_bf16_f32 v180, v98, -v99
    v_pk_mul_f32 v[88:89], v[62:63], v[64:65] op_sel:[1,1] op_sel_hi:[1,0] neg_lo:[1,0]
    v_pk_mul_f32 v[92:93], v[72:73], v[68:69] op_sel:[1,1] op_sel_hi:[1,0] neg_lo:[1,0]
    v_pk_mul_f32 v[96:97], v[68:69], v[62:63] op_sel:[1,1] op_sel_hi:[1,0] neg_lo:[1,0]
    v_pk_fma_f32 v[90:91], v[62:63], v[64:65], v[88:89] op_sel:[0,0,0] op_sel_hi:[0,1,1]
    v_pk_fma_f32 v[76:77], v[72:73], v[68:69], v[92:93] op_sel:[0,0,0] op_sel_hi:[0,1,1]
    v_pk_fma_f32 v[98:99], v[68:69], v[62:63], v[96:97] op_sel:[0,0,0] op_sel_hi:[0,1,1]
    v_cvt_pk_bf16_f32 v176, v90, -v91
    v_cvt_pk_bf16_f32 v192, v76, -v77
    v_cvt_pk_bf16_f32 v183, v98, -v99
    v_pk_mul_f32 v[88:89], v[56:57], v[60:61] op_sel:[1,1] op_sel_hi:[1,0] neg_lo:[1,0]
    v_pk_mul_f32 v[92:93], v[72:73], v[70:71] op_sel:[1,1] op_sel_hi:[1,0] neg_lo:[1,0]
    v_pk_mul_f32 v[96:97], v[70:71], v[62:63] op_sel:[1,1] op_sel_hi:[1,0] neg_lo:[1,0]
    v_pk_fma_f32 v[90:91], v[56:57], v[60:61], v[88:89] op_sel:[0,0,0] op_sel_hi:[0,1,1]
    v_pk_fma_f32 v[78:79], v[72:73], v[70:71], v[92:93] op_sel:[0,0,0] op_sel_hi:[0,1,1]
    v_pk_fma_f32 v[98:99], v[70:71], v[62:63], v[96:97] op_sel:[0,0,0] op_sel_hi:[0,1,1]
    v_cvt_pk_bf16_f32 v178, v90, -v91
    v_cvt_pk_bf16_f32 v194, v78, -v79
    v_cvt_pk_bf16_f32 v186, v98, -v99
    v_pk_mul_f32 v[88:89], v[56:57], v[62:63] op_sel:[1,1] op_sel_hi:[1,0] neg_lo:[1,0]
    v_pk_mul_f32 v[92:93], v[70:71], v[52:53] op_sel:[1,1] op_sel_hi:[1,0] neg_lo:[1,0]
    v_pk_mul_f32 v[96:97], v[68:69], v[52:53] op_sel:[1,1] op_sel_hi:[1,0] neg_lo:[1,0]
    v_pk_fma_f32 v[90:91], v[56:57], v[62:63], v[88:89] op_sel:[0,0,0] op_sel_hi:[0,1,1]
    v_pk_fma_f32 v[94:95], v[70:71], v[52:53], v[92:93] op_sel:[0,0,0] op_sel_hi:[0,1,1]
    v_pk_fma_f32 v[98:99], v[68:69], v[52:53], v[96:97] op_sel:[0,0,0] op_sel_hi:[0,1,1]
    v_cvt_pk_bf16_f32 v179, v90, -v91
    v_cvt_pk_bf16_f32 v187, v94, -v95
    v_cvt_pk_bf16_f32 v184, v98, -v99
    v_pk_mul_f32 v[88:89], v[72:73], v[52:53] op_sel:[1,1] op_sel_hi:[1,0] neg_lo:[1,0]
    v_pk_mul_f32 v[92:93], v[74:75], v[52:53] op_sel:[1,1] op_sel_hi:[1,0] neg_lo:[1,0]
    v_pk_mul_f32 v[96:97], v[76:77], v[52:53] op_sel:[1,1] op_sel_hi:[1,0] neg_lo:[1,0]
    v_pk_mul_f32 v[100:101], v[78:79], v[52:53] op_sel:[1,1] op_sel_hi:[1,0] neg_lo:[1,0]
    v_pk_fma_f32 v[90:91], v[72:73], v[52:53], v[88:89] op_sel:[0,0,0] op_sel_hi:[0,1,1]
    v_pk_fma_f32 v[94:95], v[74:75], v[52:53], v[92:93] op_sel:[0,0,0] op_sel_hi:[0,1,1]
    v_pk_fma_f32 v[98:99], v[76:77], v[52:53], v[96:97] op_sel:[0,0,0] op_sel_hi:[0,1,1]
    v_pk_fma_f32 v[102:103], v[78:79], v[52:53], v[100:101] op_sel:[0,0,0] op_sel_hi:[0,1,1]
    v_cvt_pk_bf16_f32 v189, v90, -v91
    v_cvt_pk_bf16_f32 v191, v94, -v95
    v_cvt_pk_bf16_f32 v193, v98, -v99
    v_cvt_pk_bf16_f32 v195, v102, -v103
    s_barrier
    s_add_u32 m0, s19, s38
    s_and_b32 s22, s22, 15
    buffer_load_dwordx4 v6, s[12:15], s18 offen offset:0 lds
    buffer_load_dwordx4 v7, s[12:15], s18 offen offset:1024 lds
    buffer_load_dwordx4 v8, s[12:15], s18 offen offset:2048 lds
    s_add_u32 s19, s19, 40960
    s_cmp_eq_u32 s19, 163840
    s_cselect_b32 s19, 40960, s19
    s_and_b32 s16, s23, 3
    s_xor_b32 s17, s22, s16
    s_xor_b32 s17, s17, s100
    s_lshl_b32 s16, s17, 7
    s_mul_i32 s17, s17, 393216
    s_add_u32 m0, s19, s21
    s_add_u32 s18, s17, s39
    s_add_u32 s17, s17, s48
    buffer_load_dwordx4 v6, s[12:15], s17 offen offset:0 lds
    buffer_load_dwordx4 v7, s[12:15], s17 offen offset:1024 lds
    buffer_load_dwordx4 v8, s[12:15], s17 offen offset:2048 lds
    s_add_u32 m0, s19, s20
    s_add_u32 s22, s22, 1
    buffer_load_dwordx4 v2, s[8:11], s16 offen offset:0 lds
    buffer_load_dwordx4 v3, s[8:11], s16 offen offset:1024 lds
    buffer_load_dwordx4 v4, s[8:11], s16 offen offset:2048 lds
    buffer_load_dwordx4 v5, s[8:11], s16 offen offset:3072 lds
    s_add_u32 m0, s19, s38
    s_and_b32 s22, s22, 15
    buffer_load_dwordx4 v6, s[12:15], s18 offen offset:0 lds
    buffer_load_dwordx4 v7, s[12:15], s18 offen offset:1024 lds
    buffer_load_dwordx4 v8, s[12:15], s18 offen offset:2048 lds
    s_add_u32 s19, s19, 40960
    s_cmp_eq_u32 s19, 163840
    s_cselect_b32 s19, 40960, s19
    s_waitcnt vmcnt(10)
    s_barrier
    s_and_b32 s16, s23, 3
    s_xor_b32 s17, s22, s16
    s_xor_b32 s17, s17, s100
    s_lshl_b32 s16, s17, 7
    s_mul_i32 s17, s17, 393216
    s_add_u32 m0, s19, s21
    s_add_u32 s18, s17, s39
    s_add_u32 s17, s17, s48
    buffer_load_dwordx4 v6, s[12:15], s17 offen offset:0 lds
    buffer_load_dwordx4 v7, s[12:15], s17 offen offset:1024 lds
    buffer_load_dwordx4 v8, s[12:15], s17 offen offset:2048 lds
    s_add_u32 m0, s19, s20
    s_add_u32 s22, s22, 1
    buffer_load_dwordx4 v2, s[8:11], s16 offen offset:0 lds
    buffer_load_dwordx4 v3, s[8:11], s16 offen offset:1024 lds
    buffer_load_dwordx4 v4, s[8:11], s16 offen offset:2048 lds
    buffer_load_dwordx4 v5, s[8:11], s16 offen offset:3072 lds
    s_add_u32 m0, s19, s38
    s_and_b32 s22, s22, 15
    buffer_load_dwordx4 v6, s[12:15], s18 offen offset:0 lds
    buffer_load_dwordx4 v7, s[12:15], s18 offen offset:1024 lds
    buffer_load_dwordx4 v8, s[12:15], s18 offen offset:2048 lds
    s_add_u32 s19, s19, 40960
    s_cmp_eq_u32 s19, 163840
    s_cselect_b32 s19, 40960, s19
    v_mul_f32 v88, v45, v59
    v_mul_f32 v90, v47, v59
    v_mul_f32 v92, v49, v59
    v_mul_f32 v94, v51, v59
    v_mul_f32 v89, v45, v58
    v_mul_f32 v91, v47, v58
    v_mul_f32 v93, v49, v58
    v_mul_f32 v95, v51, v58
    v_fma_f32 v45, v44, v59, v89
    v_fma_f32 v47, v46, v59, v91
    v_fma_f32 v49, v48, v59, v93
    v_fma_f32 v51, v50, v59, v95
    v_fma_f32 v44, v44, v58, -v88
    v_fma_f32 v46, v46, v58, -v90
    v_fma_f32 v48, v48, v58, -v92
    v_fma_f32 v50, v50, v58, -v94
    v_cvt_pk_bf16_f32 v200, v44, v45
    v_cvt_pk_bf16_f32 v201, v46, v47
    v_cvt_pk_bf16_f32 v202, v48, v49
    v_cvt_pk_bf16_f32 v203, v50, v51
    v_mul_f32 v88, v45, v59
    v_mul_f32 v90, v47, v59
    v_mul_f32 v92, v49, v59
    v_mul_f32 v94, v51, v59
    v_mul_f32 v89, v45, v58
    v_mul_f32 v91, v47, v58
    v_mul_f32 v93, v49, v58
    v_mul_f32 v95, v51, v58
    v_fma_f32 v45, v44, v59, v89
    v_fma_f32 v47, v46, v59, v91
    v_fma_f32 v49, v48, v59, v93
    v_fma_f32 v51, v50, v59, v95
    v_fma_f32 v44, v44, v58, -v88
    v_fma_f32 v46, v46, v58, -v90
    v_fma_f32 v48, v48, v58, -v92
    v_fma_f32 v50, v50, v58, -v94
    v_cvt_pk_bf16_f32 v204, v44, v45
    v_cvt_pk_bf16_f32 v205, v46, v47
    v_cvt_pk_bf16_f32 v206, v48, v49
    v_cvt_pk_bf16_f32 v207, v50, v51
    v_mul_f32 v88, v45, v59
    v_mul_f32 v90, v47, v59
    v_mul_f32 v92, v49, v59
    v_mul_f32 v94, v51, v59
    v_mul_f32 v89, v45, v58
    v_mul_f32 v91, v47, v58
    v_mul_f32 v93, v49, v58
    v_mul_f32 v95, v51, v58
    v_fma_f32 v45, v44, v59, v89
    v_fma_f32 v47, v46, v59, v91
    v_fma_f32 v49, v48, v59, v93
    v_fma_f32 v51, v50, v59, v95
    v_fma_f32 v44, v44, v58, -v88
    v_fma_f32 v46, v46, v58, -v90
    v_fma_f32 v48, v48, v58, -v92
    v_fma_f32 v50, v50, v58, -v94
    v_cvt_pk_bf16_f32 v208, v44, v45
    v_cvt_pk_bf16_f32 v209, v46, v47
    v_cvt_pk_bf16_f32 v210, v48, v49
    v_cvt_pk_bf16_f32 v211, v50, v51
    v_mul_f32 v88, v45, v59
    v_mul_f32 v90, v47, v59
    v_mul_f32 v92, v49, v59
    v_mul_f32 v94, v51, v59
    v_mul_f32 v89, v45, v58
    v_mul_f32 v91, v47, v58
    v_mul_f32 v93, v49, v58
    v_mul_f32 v95, v51, v58
    v_fma_f32 v45, v44, v59, v89
    v_fma_f32 v47, v46, v59, v91
    v_fma_f32 v49, v48, v59, v93
    v_fma_f32 v51, v50, v59, v95
    v_fma_f32 v44, v44, v58, -v88
    v_fma_f32 v46, v46, v58, -v90
    v_fma_f32 v48, v48, v58, -v92
    v_fma_f32 v50, v50, v58, -v94
    v_cvt_pk_bf16_f32 v212, v44, v45
    v_cvt_pk_bf16_f32 v213, v46, v47
    v_cvt_pk_bf16_f32 v214, v48, v49
    v_cvt_pk_bf16_f32 v215, v50, v51
    v_mul_f32 v88, v45, v59
    v_mul_f32 v90, v47, v59
    v_mul_f32 v92, v49, v59
    v_mul_f32 v94, v51, v59
    v_mul_f32 v89, v45, v58
    v_mul_f32 v91, v47, v58
    v_mul_f32 v93, v49, v58
    v_mul_f32 v95, v51, v58
    v_fma_f32 v45, v44, v59, v89
    v_fma_f32 v47, v46, v59, v91
    v_fma_f32 v49, v48, v59, v93
    v_fma_f32 v51, v50, v59, v95
    v_fma_f32 v44, v44, v58, -v88
    v_fma_f32 v46, v46, v58, -v90
    v_fma_f32 v48, v48, v58, -v92
    v_fma_f32 v50, v50, v58, -v94
    v_cvt_pk_bf16_f32 v216, v44, v45
    v_cvt_pk_bf16_f32 v217, v46, v47
    v_cvt_pk_bf16_f32 v218, v48, v49
    v_cvt_pk_bf16_f32 v219, v50, v51
    v_mul_f32 v88, v45, v59
    v_mul_f32 v90, v47, v59
    v_mul_f32 v92, v49, v59
    v_mul_f32 v94, v51, v59
    v_mul_f32 v89, v45, v58
    v_mul_f32 v91, v47, v58
    v_mul_f32 v93, v49, v58
    v_mul_f32 v95, v51, v58
    v_fma_f32 v45, v44, v59, v89
    v_fma_f32 v47, v46, v59, v91
    v_fma_f32 v49, v48, v59, v93
    v_fma_f32 v51, v50, v59, v95
    v_fma_f32 v44, v44, v58, -v88
    v_fma_f32 v46, v46, v58, -v90
    v_fma_f32 v48, v48, v58, -v92
    v_fma_f32 v50, v50, v58, -v94
    v_cvt_pk_bf16_f32 v220, v44, v45
    v_cvt_pk_bf16_f32 v221, v46, v47
    v_cvt_pk_bf16_f32 v222, v48, v49
    v_cvt_pk_bf16_f32 v223, v50, v51
    v_mul_f32 v88, v45, v59
    v_mul_f32 v90, v47, v59
    v_mul_f32 v92, v49, v59
    v_mul_f32 v94, v51, v59
    v_mul_f32 v89, v45, v58
    v_mul_f32 v91, v47, v58
    v_mul_f32 v93, v49, v58
    v_mul_f32 v95, v51, v58
    v_fma_f32 v45, v44, v59, v89
    v_fma_f32 v47, v46, v59, v91
    v_fma_f32 v49, v48, v59, v93
    v_fma_f32 v51, v50, v59, v95
    v_fma_f32 v44, v44, v58, -v88
    v_fma_f32 v46, v46, v58, -v90
    v_fma_f32 v48, v48, v58, -v92
    v_fma_f32 v50, v50, v58, -v94
    v_cvt_pk_bf16_f32 v224, v44, v45
    v_cvt_pk_bf16_f32 v225, v46, v47
    v_cvt_pk_bf16_f32 v226, v48, v49
    v_cvt_pk_bf16_f32 v227, v50, v51
    s_waitcnt vmcnt(10)
    s_barrier
    s_and_b32 s16, s23, 3
    s_xor_b32 s17, s22, s16
    s_xor_b32 s17, s17, s100
    s_lshl_b32 s16, s17, 7
    s_mul_i32 s17, s17, 393216
    s_add_u32 m0, s19, s21
    s_add_u32 s18, s17, s39
    s_add_u32 s17, s17, s48
    buffer_load_dwordx4 v6, s[12:15], s17 offen offset:0 lds
    buffer_load_dwordx4 v7, s[12:15], s17 offen offset:1024 lds
    buffer_load_dwordx4 v8, s[12:15], s17 offen offset:2048 lds
    s_add_u32 m0, s19, s20
    s_add_u32 s22, s22, 1
    buffer_load_dwordx4 v2, s[8:11], s16 offen offset:0 lds
    buffer_load_dwordx4 v3, s[8:11], s16 offen offset:1024 lds
    buffer_load_dwordx4 v4, s[8:11], s16 offen offset:2048 lds
    buffer_load_dwordx4 v5, s[8:11], s16 offen offset:3072 lds
    s_add_u32 m0, s19, s38
    s_and_b32 s22, s22, 15
    buffer_load_dwordx4 v6, s[12:15], s18 offen offset:0 lds
    buffer_load_dwordx4 v7, s[12:15], s18 offen offset:1024 lds
    buffer_load_dwordx4 v8, s[12:15], s18 offen offset:2048 lds
    s_add_u32 s19, s19, 40960
    s_cmp_eq_u32 s19, 163840
    s_cselect_b32 s19, 40960, s19
    s_waitcnt vmcnt(10)
    s_barrier
    s_and_b32 s16, s23, 3
    s_xor_b32 s17, s22, s16
    s_xor_b32 s17, s17, s100
    s_lshl_b32 s16, s17, 7
    s_mul_i32 s17, s17, 393216
    s_add_u32 m0, s19, s21
    s_add_u32 s18, s17, s39
    s_add_u32 s17, s17, s48
    buffer_load_dwordx4 v6, s[12:15], s17 offen offset:0 lds
    buffer_load_dwordx4 v7, s[12:15], s17 offen offset:1024 lds
    buffer_load_dwordx4 v8, s[12:15], s17 offen offset:2048 lds
    s_add_u32 m0, s19, s20
    s_add_u32 s22, s22, 1
    buffer_load_dwordx4 v2, s[8:11], s16 offen offset:0 lds
    buffer_load_dwordx4 v3, s[8:11], s16 offen offset:1024 lds
    buffer_load_dwordx4 v4, s[8:11], s16 offen offset:2048 lds
    buffer_load_dwordx4 v5, s[8:11], s16 offen offset:3072 lds
    s_add_u32 m0, s19, s38
    s_and_b32 s22, s22, 15
    buffer_load_dwordx4 v6, s[12:15], s18 offen offset:0 lds
    buffer_load_dwordx4 v7, s[12:15], s18 offen offset:1024 lds
    buffer_load_dwordx4 v8, s[12:15], s18 offen offset:2048 lds
    s_add_u32 s19, s19, 40960
    s_cmp_eq_u32 s19, 163840
    s_cselect_b32 s19, 40960, s19
    s_waitcnt vmcnt(10)
    s_barrier
    s_and_b32 s16, s23, 3
    s_xor_b32 s17, s22, s16
    s_xor_b32 s17, s17, s100
    s_lshl_b32 s16, s17, 7
    s_mul_i32 s17, s17, 393216
    s_add_u32 m0, s19, s21
    s_add_u32 s18, s17, s39
    s_add_u32 s17, s17, s48
    buffer_load_dwordx4 v6, s[12:15], s17 offen offset:0 lds
    buffer_load_dwordx4 v7, s[12:15], s17 offen offset:1024 lds
    buffer_load_dwordx4 v8, s[12:15], s17 offen offset:2048 lds
    s_add_u32 m0, s19, s20
    s_add_u32 s22, s22, 1
    buffer_load_dwordx4 v2, s[8:11], s16 offen offset:0 lds
    buffer_load_dwordx4 v3, s[8:11], s16 offen offset:1024 lds
    buffer_load_dwordx4 v4, s[8:11], s16 offen offset:2048 lds
    buffer_load_dwordx4 v5, s[8:11], s16 offen offset:3072 lds
    s_add_u32 m0, s19, s38
    s_and_b32 s22, s22, 15
    buffer_load_dwordx4 v6, s[12:15], s18 offen offset:0 lds
    buffer_load_dwordx4 v7, s[12:15], s18 offen offset:1024 lds
    buffer_load_dwordx4 v8, s[12:15], s18 offen offset:2048 lds
    s_add_u32 s19, s19, 40960
    s_cmp_eq_u32 s19, 163840
    s_cselect_b32 s19, 40960, s19
    s_waitcnt vmcnt(10)
    s_barrier
    global_load_dwordx2 v[10:11], v9, s[52:53] sc1
    s_and_b32 s16, s23, 3
    s_xor_b32 s17, s22, s16
    s_xor_b32 s17, s17, s100
    s_lshl_b32 s16, s17, 7
    s_mul_i32 s17, s17, 393216
    s_add_u32 m0, s19, s21
    s_add_u32 s18, s17, s39
    s_add_u32 s17, s17, s48
    buffer_load_dwordx4 v6, s[12:15], s17 offen offset:0 lds
    buffer_load_dwordx4 v7, s[12:15], s17 offen offset:1024 lds
    buffer_load_dwordx4 v8, s[12:15], s17 offen offset:2048 lds
    s_add_u32 m0, s19, s20
    s_add_u32 s22, s22, 1
    buffer_load_dwordx4 v2, s[8:11], s16 offen offset:0 lds
    buffer_load_dwordx4 v3, s[8:11], s16 offen offset:1024 lds
    buffer_load_dwordx4 v4, s[8:11], s16 offen offset:2048 lds
    buffer_load_dwordx4 v5, s[8:11], s16 offen offset:3072 lds
    s_add_u32 m0, s19, s38
    s_and_b32 s22, s22, 15
    buffer_load_dwordx4 v6, s[12:15], s18 offen offset:0 lds
    buffer_load_dwordx4 v7, s[12:15], s18 offen offset:1024 lds
    buffer_load_dwordx4 v8, s[12:15], s18 offen offset:2048 lds
    s_add_u32 s19, s19, 40960
    s_cmp_eq_u32 s19, 163840
    s_cselect_b32 s19, 40960, s19
    s_waitcnt vmcnt(11)
    s_barrier
    s_xor_b32 s17, s22, s23
    s_xor_b32 s17, s17, s100
    s_lshl_b32 s16, s17, 7
    s_mul_i32 s17, s17, 393216
    s_add_u32 m0, s19, s21
    s_add_u32 s18, s17, s39
    s_add_u32 s17, s17, s48
    buffer_load_dwordx4 v6, s[12:15], s17 offen offset:0 lds
    buffer_load_dwordx4 v7, s[12:15], s17 offen offset:1024 lds
    buffer_load_dwordx4 v8, s[12:15], s17 offen offset:2048 lds
    s_add_u32 m0, s19, s20
    s_add_u32 s22, s22, 1
    buffer_load_dwordx4 v2, s[8:11], s16 offen offset:0 lds
    buffer_load_dwordx4 v3, s[8:11], s16 offen offset:1024 lds
    buffer_load_dwordx4 v4, s[8:11], s16 offen offset:2048 lds
    buffer_load_dwordx4 v5, s[8:11], s16 offen offset:3072 lds
    s_add_u32 m0, s19, s38
    s_and_b32 s22, s22, 15
    buffer_load_dwordx4 v6, s[12:15], s18 offen offset:0 lds
    buffer_load_dwordx4 v7, s[12:15], s18 offen offset:1024 lds
    buffer_load_dwordx4 v8, s[12:15], s18 offen offset:2048 lds
    s_add_u32 s19, s19, 40960
    s_cmp_eq_u32 s19, 163840
    s_cselect_b32 s19, 40960, s19
    s_waitcnt vmcnt(10)
    s_barrier
    s_waitcnt vmcnt(20)
    s_mov_b32 s60, 0
S_non:
    v_cmp_ne_u64 vcc, 0, v[10:11]
    s_add_u32 s60, s60, 1
    s_nop 3
    s_cbranch_vccnz S_nonok
    s_cmp_gt_u32 s60, 1048576
    s_cbranch_scc1 S_nonok
    global_load_dwordx2 v[10:11], v9, s[52:53] sc1
    s_waitcnt vmcnt(0)
    s_branch S_non
S_nonok:
    s_getreg_b32 s32, hwreg(HW_REG_XCC_ID, 0, 4)
    v_or_b32 v228, s32, v10
    v_mov_b32 v229, v11
    s_cmp_eq_u32 s28, 0
    s_cselect_b32 s60, s62, 0x7ffffff0
    s_mov_b64 exec, 1
    buffer_store_dwordx2 v[228:229], v9, s[40:43], s60 offen sc1
    s_mov_b64 exec, -1
    s_xor_b32 s17, s22, s23
    s_xor_b32 s17, s17, s100
    s_lshl_b32 s16, s17, 7
    s_mul_i32 s17, s17, 393216
    s_add_u32 m0, s19, s21
    s_add_u32 s18, s17, s39
    s_add_u32 s17, s17, s48
    buffer_load_dwordx4 v6, s[12:15], s17 offen offset:0 lds
    buffer_load_dwordx4 v7, s[12:15], s17 offen offset:1024 lds
    buffer_load_dwordx4 v8, s[12:15], s17 offen offset:2048 lds
    s_add_u32 m0, s19, s20
    s_add_u32 s22, s22, 1
    buffer_load_dwordx4 v2, s[8:11], s16 offen offset:0 lds
    buffer_load_dwordx4 v3, s[8:11], s16 offen offset:1024 lds
    buffer_load_dwordx4 v4, s[8:11], s16 offen offset:2048 lds
    buffer_load_dwordx4 v5, s[8:11], s16 offen offset:3072 lds
    s_add_u32 m0, s19, s38
    s_and_b32 s22, s22, 15
    buffer_load_dwordx4 v6, s[12:15], s18 offen offset:0 lds
    buffer_load_dwordx4 v7, s[12:15], s18 offen offset:1024 lds
    buffer_load_dwordx4 v8, s[12:15], s18 offen offset:2048 lds
    s_add_u32 s19, s19, 40960
    s_cmp_eq_u32 s19, 163840
    s_cselect_b32 s19, 40960, s19
    s_waitcnt vmcnt(11)
    s_barrier
    s_xor_b32 s17, s22, s23
    s_xor_b32 s17, s17, s100
    s_lshl_b32 s16, s17, 7
    s_mul_i32 s17, s17, 393216
    s_add_u32 m0, s19, s21
    s_add_u32 s18, s17, s39
    s_add_u32 s17, s17, s48
    buffer_load_dwordx4 v6, s[12:15], s17 offen offset:0 lds
    buffer_load_dwordx4 v7, s[12:15], s17 offen offset:1024 lds
    buffer_load_dwordx4 v8, s[12:15], s17 offen offset:2048 lds
    s_add_u32 m0, s19, s20
    s_add_u32 s22, s22, 1
    buffer_load_dwordx4 v2, s[8:11], s16 offen offset:0 lds
    buffer_load_dwordx4 v3, s[8:11], s16 offen offset:1024 lds
    buffer_load_dwordx4 v4, s[8:11], s16 offen offset:2048 lds
    buffer_load_dwordx4 v5, s[8:11], s16 offen offset:3072 lds
    s_add_u32 m0, s19, s38
    s_and_b32 s22, s22, 15
    buffer_load_dwordx4 v6, s[12:15], s18 offen offset:0 lds
    buffer_load_dwordx4 v7, s[12:15], s18 offen offset:1024 lds
    buffer_load_dwordx4 v8, s[12:15], s18 offen offset:2048 lds
    s_add_u32 s19, s19, 40960
    s_cmp_eq_u32 s19, 163840
    s_cselect_b32 s19, 40960, s19
    s_waitcnt vmcnt(10)
    s_barrier
    s_xor_b32 s17, s22, s23
    s_xor_b32 s17, s17, s100
    s_lshl_b32 s16, s17, 7
    s_mul_i32 s17, s17, 393216
    s_add_u32 m0, s19, s21
    s_add_u32 s18, s17, s39
    s_add_u32 s17, s17, s48
    buffer_load_dwordx4 v6, s[12:15], s17 offen offset:0 lds
    buffer_load_dwordx4 v7, s[12:15], s17 offen offset:1024 lds
    buffer_load_dwordx4 v8, s[12:15], s17 offen offset:2048 lds
    s_add_u32 m0, s19, s20
    s_add_u32 s22, s22, 1
    buffer_load_dwordx4 v2, s[8:11], s16 offen offset:0 lds
    buffer_load_dwordx4 v3, s[8:11], s16 offen offset:1024 lds
    buffer_load_dwordx4 v4, s[8:11], s16 offen offset:2048 lds
    buffer_load_dwordx4 v5, s[8:11], s16 offen offset:3072 lds
    s_add_u32 m0, s19, s38
    s_and_b32 s22, s22, 15
    buffer_load_dwordx4 v6, s[12:15], s18 offen offset:0 lds
    buffer_load_dwordx4 v7, s[12:15], s18 offen offset:1024 lds
    buffer_load_dwordx4 v8, s[12:15], s18 offen offset:2048 lds
    s_add_u32 s19, s19, 40960
    s_cmp_eq_u32 s19, 163840
    s_cselect_b32 s19, 40960, s19
    s_waitcnt vmcnt(10)
    s_barrier
    s_xor_b32 s17, s22, s23
    s_xor_b32 s17, s17, s100
    s_lshl_b32 s16, s17, 7
    s_mul_i32 s17, s17, 393216
    s_add_u32 m0, s19, s21
    s_add_u32 s18, s17, s39
    s_add_u32 s17, s17, s48
    buffer_load_dwordx4 v6, s[12:15], s17 offen offset:0 lds
    buffer_load_dwordx4 v7, s[12:15], s17 offen offset:1024 lds
    buffer_load_dwordx4 v8, s[12:15], s17 offen offset:2048 lds
    s_add_u32 m0, s19, s20
    s_add_u32 s22, s22, 1
    buffer_load_dwordx4 v2, s[8:11], s16 offen offset:0 lds
    buffer_load_dwordx4 v3, s[8:11], s16 offen offset:1024 lds
    buffer_load_dwordx4 v4, s[8:11], s16 offen offset:2048 lds
    buffer_load_dwordx4 v5, s[8:11], s16 offen offset:3072 lds
    s_add_u32 m0, s19, s38
    s_and_b32 s22, s22, 15
    buffer_load_dwordx4 v6, s[12:15], s18 offen offset:0 lds
    buffer_load_dwordx4 v7, s[12:15], s18 offen offset:1024 lds
    buffer_load_dwordx4 v8, s[12:15], s18 offen offset:2048 lds
    s_add_u32 s19, s19, 40960
    s_cmp_eq_u32 s19, 163840
    s_cselect_b32 s19, 40960, s19
    s_waitcnt vmcnt(10)
    s_barrier
    s_xor_b32 s17, s22, s23
    s_xor_b32 s17, s17, s100
    s_lshl_b32 s16, s17, 7
    s_mul_i32 s17, s17, 393216
    s_add_u32 m0, s19, s21
    s_add_u32 s18, s17, s39
    s_add_u32 s17, s17, s48
    buffer_load_dwordx4 v6, s[12:15], s17 offen offset:0 lds
    buffer_load_dwordx4 v7, s[12:15], s17 offen offset:1024 lds
    buffer_load_dwordx4 v8, s[12:15], s17 offen offset:2048 lds
    s_add_u32 m0, s19, s20
    s_add_u32 s22, s22, 1
    buffer_load_dwordx4 v2, s[8:11], s16 offen offset:0 lds
    buffer_load_dwordx4 v3, s[8:11], s16 offen offset:1024 lds
    buffer_load_dwordx4 v4, s[8:11], s16 offen offset:2048 lds
    buffer_load_dwordx4 v5, s[8:11], s16 offen offset:3072 lds
    s_add_u32 m0, s19, s38
    s_and_b32 s22, s22, 15
    buffer_load_dwordx4 v6, s[12:15], s18 offen offset:0 lds
    buffer_load_dwordx4 v7, s[12:15], s18 offen offset:1024 lds
    buffer_load_dwordx4 v8, s[12:15], s18 offen offset:2048 lds
    s_add_u32 s19, s19, 40960
    s_cmp_eq_u32 s19, 163840
    s_cselect_b32 s19, 40960, s19
    s_waitcnt vmcnt(10)
    s_barrier
    buffer_load_dwordx2 v[252:253], v14, s[40:43], s63 offen sc1
    s_xor_b32 s17, s22, s23
    s_xor_b32 s17, s17, s100
    s_lshl_b32 s16, s17, 7
    s_mul_i32 s17, s17, 393216
    s_add_u32 m0, s19, s21
    s_add_u32 s18, s17, s39
    s_add_u32 s17, s17, s48
    buffer_load_dwordx4 v6, s[12:15], s17 offen offset:0 lds
    buffer_load_dwordx4 v7, s[12:15], s17 offen offset:1024 lds
    buffer_load_dwordx4 v8, s[12:15], s17 offen offset:2048 lds
    s_add_u32 m0, s19, s20
    s_add_u32 s22, s22, 1
    buffer_load_dwordx4 v2, s[8:11], s16 offen offset:0 lds
    buffer_load_dwordx4 v3, s[8:11], s16 offen offset:1024 lds
    buffer_load_dwordx4 v4, s[8:11], s16 offen offset:2048 lds
    buffer_load_dwordx4 v5, s[8:11], s16 offen offset:3072 lds
    s_add_u32 m0, s19, s38
    s_and_b32 s22, s22, 15
    buffer_load_dwordx4 v6, s[12:15], s18 offen offset:0 lds
    buffer_load_dwordx4 v7, s[12:15], s18 offen offset:1024 lds
    buffer_load_dwordx4 v8, s[12:15], s18 offen offset:2048 lds
    s_add_u32 s19, s19, 40960
    s_cmp_eq_u32 s19, 163840
    s_cselect_b32 s19, 40960, s19
    s_waitcnt vmcnt(11)
    s_barrier
    s_xor_b32 s17, s22, s23
    s_xor_b32 s17, s17, s100
    s_lshl_b32 s16, s17, 7
    s_mul_i32 s17, s17, 393216
    s_add_u32 m0, s19, s21
    s_add_u32 s18, s17, s39
    s_add_u32 s17, s17, s48
    buffer_load_dwordx4 v6, s[12:15], s17 offen offset:0 lds
    buffer_load_dwordx4 v7, s[12:15], s17 offen offset:1024 lds
    buffer_load_dwordx4 v8, s[12:15], s17 offen offset:2048 lds
    s_add_u32 m0, s19, s20
    s_add_u32 s22, s22, 1
    buffer_load_dwordx4 v2, s[8:11], s16 offen offset:0 lds
    buffer_load_dwordx4 v3, s[8:11], s16 offen offset:1024 lds
    buffer_load_dwordx4 v4, s[8:11], s16 offen offset:2048 lds
    buffer_load_dwordx4 v5, s[8:11], s16 offen offset:3072 lds
    s_add_u32 m0, s19, s38
    s_and_b32 s22, s22, 15
    buffer_load_dwordx4 v6, s[12:15], s18 offen offset:0 lds
    buffer_load_dwordx4 v7, s[12:15], s18 offen offset:1024 lds
    buffer_load_dwordx4 v8, s[12:15], s18 offen offset:2048 lds
    s_add_u32 s19, s19, 40960
    s_cmp_eq_u32 s19, 163840
    s_cselect_b32 s19, 40960, s19
    s_lshl_b32 s32, s68, 16
    s_lshl_b32 s33, s35, 7
    s_add_u32 s32, s32, s33
    s_mov_b32 m0, s69
    s_nop 0
    buffer_load_dwordx4 v12, s[76:79], s32 offen offset:0 lds
    s_add_u32 s32, s32, 15360
    buffer_load_dwordx4 v12, s[76:79], s32 offen offset:1024 lds
    s_add_u32 s32, s32, 15360
    buffer_load_dwordx4 v12, s[76:79], s32 offen offset:2048 lds
    s_add_u32 s32, s32, 15360
    buffer_load_dwordx4 v12, s[76:79], s32 offen offset:3072 lds
    buffer_load_dword v231, v230, s[40:43], 0 offen sc1
    s_waitcnt vmcnt(15)
    s_barrier
    s_waitcnt vmcnt(25)
    s_mov_b32 s58, 0
SX_chk:
    v_and_b32 v254, -16, v252
    v_mov_b32 v255, v253
    v_cmp_ne_u64 vcc, v[254:255], v[10:11]
    s_add_u32 s58, s58, 1
    s_cbranch_vccz SX_ok
    s_cmp_gt_u32 s58, 1048576
    s_cbranch_scc1 SX_ok
    buffer_load_dwordx2 v[252:253], v14, s[40:43], s63 offen sc1
    s_waitcnt vmcnt(0)
    s_branch SX_chk
SX_ok:
    v_cmp_ne_u64 vcc, v[252:253], v[228:229]
    v_mov_b32 v252, v10
    v_mov_b32 v253, v11
    s_cmp_eq_u64 vcc, 0
    s_cselect_b32 s49, 1, 0
    v_mov_b32 v254, s49
    ds_write_b96 v9, v[252:254] offset:40288
    v_lshrrev_b32 v36, 3, v1
    v_and_b32 v37, 7, v1
    v_and_b32 v8, 6, v36
    v_xor_b32 v37, v37, v8
    v_lshlrev_b32 v37, 4, v37
    v_lshl_add_u32 v37, v36, 11, v37
    s_lshl_b32 s32, s71, 7
    v_add_u32 v8, s32, v37
    s_lshl_b32 s75, s72, 2
    s_mul_i32 s82, s28, 10
    s_lshl_b32 s83, s28, 1
    v_and_b32 v36, 31, v1
    v_lshrrev_b32 v37, 5, v1
    v_mul_u32_u24 v38, 272, v36
    v_lshl_add_u32 v38, v37, 4, v38
    s_mul_i32 s85, s28, 10240
    v_add_u32 v33, s85, v38
    v_cmp_gt_u32 s[80:81], v36, 27
    v_subrev_u32 v39, 544, v33
    v_mov_b32 v42, 0x3f80
    v_cndmask_b32 v32, v33, v39, s[80:81]
    v_mov_b32 v40, 0
    v_mov_b32 v41, 0
    s_lshl_b32 s32, s28, 9
    s_add_u32 s32, s32, 145408
    v_lshl_add_u32 v36, v1, 3, s32
    v_mov_b32 v43, v241
    v_mov_b32 v5, 1
    v_lshrrev_b32 v2, 0, v1
    v_lshlrev_b32 v2, 11, v2
    s_and_b32 s32, s70, 3
    s_lshl_b32 s32, s32, 2
    s_add_u32 s32, s32, s28
    s_mul_i32 s32, s32, 131072
    s_lshl_b32 s33, s71, 7
    s_add_u32 s84, s32, s33
    s_add_u32 s84, s84, 0
    s_waitcnt vmcnt(5)
    s_waitcnt lgkmcnt(0)
    s_barrier
    v_bfe_u32 v16, v1, 2, 2
    v_lshrrev_b32 v17, 4, v1
    v_lshl_add_u32 v12, v16, 2, v17
    v_and_b32 v18, 3, v1
    v_lshlrev_b32 v19, 3, v18
    v_lshl_add_u32 v12, v12, 7, v19
    v_add_u32 v12, s69, v12
    v_lshlrev_b32 v13, 14, v16
    v_lshl_add_u32 v13, v17, 6, v13
    v_xor_b32 v18, s28, v18
    v_lshl_add_u32 v13, v18, 4, v13
    s_lshl_b32 s74, s27, 18
    s_lshl_b32 s33, s68, 8
    s_add_u32 s74, s74, s33
    s_add_u32 s74, s74, 0
    s_waitcnt vmcnt(1)
    ds_read_b64_tr_b16 v[16:17], v12 offset:0
    ds_read_b64_tr_b16 v[18:19], v12 offset:2048
    ds_read_b64_tr_b16 v[20:21], v12 offset:32
    ds_read_b64_tr_b16 v[22:23], v12 offset:2080
    ds_read_b64_tr_b16 v[24:25], v12 offset:64
    ds_read_b64_tr_b16 v[26:27], v12 offset:2112
    ds_read_b64_tr_b16 v[28:29], v12 offset:96
    ds_read_b64_tr_b16 v[30:31], v12 offset:2144
    s_waitcnt lgkmcnt(0)
    s_cmp_eq_u32 s49, 0
    s_cbranch_scc1 X0_slow
    buffer_store_dwordx4 v[16:19], v13, s[40:43], s74 offen
    s_add_u32 s74, s74, 65536
    buffer_store_dwordx4 v[20:23], v13, s[40:43], s74 offen
    s_add_u32 s74, s74, 65536
    buffer_store_dwordx4 v[24:27], v13, s[40:43], s74 offen
    s_add_u32 s74, s74, 65536
    buffer_store_dwordx4 v[28:31], v13, s[40:43], s74 offen
X0_back:
    buffer_load_dword v6, v2, s[44:47], s84 offen
    s_waitcnt vmcnt(1)
    s_mov_b64 exec, 1
    ds_add_rtn_u32 v12, v9, v5 offset:40264
    s_waitcnt lgkmcnt(0)
    v_readfirstlane_b32 s73, v12
    s_nop 0
    s_cmp_eq_u32 s73, 3
    s_cbranch_scc0 SU_arr
    s_cmp_eq_u32 s49, 0
    s_cbranch_scc1 X1_slow
    buffer_store_dwordx2 v[10:11], v9, s[40:43], s62 offen offset:128
X1_back:
SU_arr:
    s_mov_b64 exec, -1
    s_mov_b32 m0, s85
    s_nop 0
    ds_write_addtid_b32 v42 offset:40960
    ds_write_addtid_b32 v112 offset:41232
    ds_write_addtid_b32 v113 offset:41504
    ds_write_addtid_b32 v114 offset:41776
    ds_write_addtid_b32 v115 offset:42048
    ds_write_addtid_b32 v116 offset:42320
    ds_write_addtid_b32 v117 offset:42592
    ds_write_addtid_b32 v118 offset:42864
    ds_write_addtid_b32 v119 offset:43136
    ds_write_addtid_b32 v120 offset:43408
    ds_write_addtid_b32 v121 offset:43680
    ds_write_addtid_b32 v121 offset:44224
    ds_write_addtid_b32 v122 offset:44496
    ds_write_addtid_b32 v123 offset:44768
    ds_write_addtid_b32 v124 offset:43952
    ds_write_addtid_b32 v125 offset:45312
    ds_write_addtid_b32 v126 offset:45584
    ds_write_addtid_b32 v127 offset:45040
    ds_write_addtid_b32 v128 offset:46400
    ds_write_addtid_b32 v129 offset:46672
    ds_write_addtid_b32 v130 offset:45856
    ds_write_addtid_b32 v131 offset:46128
    ds_write_addtid_b32 v132 offset:46944
    ds_write_addtid_b32 v133 offset:47216
    ds_write_addtid_b32 v134 offset:47488
    ds_write_addtid_b32 v135 offset:47760
    ds_write_addtid_b32 v136 offset:48032
    ds_write_addtid_b32 v137 offset:48304
    ds_read_b128 v[44:47], v32 offset:40960
    ds_read_b128 v[48:51], v32 offset:40992
    ds_read_b128 v[52:55], v32 offset:41024
    ds_read_b128 v[56:59], v32 offset:41056
    ds_read_b128 v[60:63], v32 offset:41088
    ds_read_b128 v[64:67], v32 offset:41120
    ds_read_b128 v[68:71], v32 offset:41152
    ds_read_b128 v[72:75], v32 offset:41184
    ds_write_b64 v36, v[40:41]
    s_cmp_eq_u32 s73, 3
    s_cbranch_scc0 SU_oth
    s_mov_b32 s58, 0
SU_poll:
    buffer_load_dwordx2 v[12:13], v14, s[40:43], s63 offen offset:128 sc1
    s_add_u32 s58, s58, 1
    s_cmp_gt_u32 s58, 1048576
    s_cbranch_scc1 SU_pollok
    s_waitcnt vmcnt(0)
    v_cmp_ne_u64 vcc, v[12:13], v[10:11]
    s_nop 4
    s_cbranch_vccz SU_pollok
    s_branch SU_poll
SU_pollok:
    s_waitcnt vmcnt(0)
SU_rel:
    ds_write_b32 v9, v5 offset:40256
    s_branch SU_go
SU_oth:
    s_mov_b32 s58, 0
SU_lw:
    ds_read_b32 v12, v9 offset:40256
    s_add_u32 s58, s58, 1
    s_cmp_gt_u32 s58, 4194304
    s_cbranch_scc1 SU_lwok
    s_waitcnt lgkmcnt(0)
    v_cmp_gt_u32 vcc, 1, v12
    s_nop 0
    s_cbranch_vccz SU_lwok
    s_sleep 1
    s_branch SU_lw
SU_lwok:
    s_waitcnt lgkmcnt(0)
SU_go:
    s_lshl_b32 s33, s28, 12
    s_add_u32 s32, s3, s33
    s_add_u32 s32, s32, 0
    s_add_u32 m0, s33, 147456
    s_nop 0
    buffer_load_dwordx4 v15, s[40:43], s32 offen offset:0 sc1 lds
    buffer_load_dwordx4 v15, s[40:43], s32 offen offset:1024 sc1 lds
    buffer_load_dwordx4 v15, s[40:43], s32 offen offset:2048 sc1 lds
    buffer_load_dwordx4 v15, s[40:43], s32 offen offset:3072 sc1 lds
    s_waitcnt vmcnt(0)
    s_mov_b64 exec, 1
    ds_add_u32 v9, v5 offset:40200
    s_mov_b64 exec, -1
    v_bfe_u32 v36, v1, 2, 3
    v_lshrrev_b32 v37, 5, v1
    v_add3_u32 v36, v36, v37, -1
    v_and_b32 v38, 3, v36
    v_xor_b32 v38, s28, v38
    v_lshlrev_b32 v38, 4, v38
    v_lshl_add_u32 v38, v36, 8, v38
    v_and_b32 v39, 3, v1
    v_lshl_add_u32 v38, v39, 6, v38
    v_add_u32 v4, 147456, v38
    v_bfe_u32 v36, v1, 4, 1
    v_lshl_add_u32 v36, v36, 2, v39
    v_bfe_u32 v38, v1, 2, 2
    v_sub_u32 v36, v36, v38
    v_lshlrev_b32 v37, 3, v37
    v_sub_u32 v36, v36, v37
    v_lshlrev_b32 v36, 3, v36
    s_add_u32 s32, s69, 96
    v_add_u32 v3, s32, v36
    v_cmp_eq_u32 s[60:61], 0, v1
    v_and_b32 v36, 1, v1
    v_cmp_eq_u32 s[80:81], 0, v36
    v_cndmask_b32 v43, 0, v43, s[60:61]
    v_and_b32 v36, 31, v1
    v_lshrrev_b32 v37, 5, v1
    v_lshlrev_b32 v38, 4, v36
    v_add_u32 v38, s69, v38
    v_lshl_add_u32 v39, v37, 3, v38
    v_lshl_add_u32 v38, v37, 9, v38
    v_and_b32 v36, 15, v1
    v_lshlrev_b32 v36, 2, v36
    v_add_u32 v36, s69, v36
    ds_write_b32 v36, v9
    s_lshl_b32 s65, s28, 3
    s_add_u32 s65, s65, 100
    s_add_u32 s74, s69, 4352
    s_mov_b32 s64, s28
    s_and_b32 s32, s28, 2
    s_lshl_b32 s32, s32, 1
    v_mov_b32 v13, s32
    s_mov_b32 s58, 0
SH1_lw:
    ds_read_b32 v12, v13 offset:40192
    s_add_u32 s58, s58, 1
    s_cmp_gt_u32 s58, 4194304
    s_cbranch_scc1 SH1_lwok
    s_waitcnt lgkmcnt(0)
    v_cmp_gt_u32 vcc, 2, v12
    s_nop 0
    s_cbranch_vccz SH1_lwok
    s_sleep 2
    s_branch SH1_lw
SH1_lwok:
    s_waitcnt lgkmcnt(0)
    s_mov_b32 m0, s85
    s_nop 0
    ds_write_addtid_b32 v138 offset:40960
    ds_write_addtid_b32 v139 offset:41232
    ds_write_addtid_b32 v140 offset:41504
    ds_write_addtid_b32 v141 offset:41776
    ds_write_addtid_b32 v142 offset:42048
    ds_write_addtid_b32 v143 offset:42320
    ds_write_addtid_b32 v144 offset:42592
    ds_write_addtid_b32 v145 offset:42864
    ds_write_addtid_b32 v146 offset:43136
    ds_write_addtid_b32 v147 offset:43408
    ds_write_addtid_b32 v148 offset:43680
    ds_write_addtid_b32 v149 offset:43952
    ds_write_addtid_b32 v150 offset:44224
    ds_write_addtid_b32 v151 offset:44496
    ds_write_addtid_b32 v152 offset:44768
    ds_write_addtid_b32 v153 offset:45040
    ds_write_addtid_b32 v154 offset:45312
    ds_write_addtid_b32 v155 offset:45584
    ds_write_addtid_b32 v156 offset:45856
    ds_write_addtid_b32 v157 offset:46128
    ds_write_addtid_b32 v158 offset:46400
    ds_write_addtid_b32 v159 offset:46672
    ds_write_addtid_b32 v160 offset:46944
    ds_write_addtid_b32 v161 offset:47216
    ds_write_addtid_b32 v162 offset:47488
    ds_write_addtid_b32 v163 offset:47760
    ds_write_addtid_b32 v164 offset:48032
    ds_write_addtid_b32 v165 offset:48304
    ds_write_addtid_b32 v166 offset:48576
    ds_write_addtid_b32 v167 offset:48848
    ds_write_addtid_b32 v168 offset:49120
    ds_write_addtid_b32 v169 offset:49392
    ds_read_b128 v[76:79], v33 offset:40960
    ds_read_b128 v[80:83], v33 offset:40992
    ds_read_b128 v[84:87], v33 offset:41024
    ds_read_b128 v[88:91], v33 offset:41056
    ds_read_b128 v[92:95], v33 offset:41088
    ds_read_b128 v[96:99], v33 offset:41120
    ds_read_b128 v[100:103], v33 offset:41152
    ds_read_b128 v[104:107], v33 offset:41184
    ds_write_addtid_b32 v42 offset:40960
    ds_write_addtid_b32 v170 offset:41232
    ds_write_addtid_b32 v171 offset:41504
    ds_write_addtid_b32 v172 offset:41776
    ds_write_addtid_b32 v173 offset:42048
    ds_write_addtid_b32 v174 offset:42320
    ds_write_addtid_b32 v175 offset:42592
    ds_write_addtid_b32 v176 offset:42864
    ds_write_addtid_b32 v177 offset:43136
    ds_write_addtid_b32 v178 offset:43408
    ds_write_addtid_b32 v179 offset:43680
    ds_write_addtid_b32 v179 offset:44224
    ds_write_addtid_b32 v180 offset:44496
    ds_write_addtid_b32 v181 offset:44768
    ds_write_addtid_b32 v182 offset:43952
    ds_write_addtid_b32 v183 offset:45312
    ds_write_addtid_b32 v184 offset:45584
    ds_write_addtid_b32 v185 offset:45040
    ds_write_addtid_b32 v186 offset:46400
    ds_write_addtid_b32 v187 offset:46672
    ds_write_addtid_b32 v188 offset:45856
    ds_write_addtid_b32 v189 offset:46128
    ds_write_addtid_b32 v190 offset:46944
    ds_write_addtid_b32 v191 offset:47216
    ds_write_addtid_b32 v192 offset:47488
    ds_write_addtid_b32 v193 offset:47760
    ds_write_addtid_b32 v194 offset:48032
    ds_write_addtid_b32 v195 offset:48304
    ds_read_b128 v[112:115], v32 offset:40960
    ds_read_b128 v[116:119], v32 offset:40992
    ds_read_b128 v[120:123], v32 offset:41024
    ds_read_b128 v[124:127], v32 offset:41056
    ds_read_b128 v[128:131], v32 offset:41088
    ds_read_b128 v[132:135], v32 offset:41120
    ds_read_b128 v[136:139], v32 offset:41152
    ds_read_b128 v[140:143], v32 offset:41184
    ds_write_addtid_b32 v196 offset:40960
    ds_write_addtid_b32 v197 offset:41232
    ds_write_addtid_b32 v198 offset:41504
    ds_write_addtid_b32 v199 offset:41776
    ds_write_addtid_b32 v200 offset:42048
    ds_write_addtid_b32 v201 offset:42320
    ds_write_addtid_b32 v202 offset:42592
    ds_write_addtid_b32 v203 offset:42864
    ds_write_addtid_b32 v204 offset:43136
    ds_write_addtid_b32 v205 offset:43408
    ds_write_addtid_b32 v206 offset:43680
    ds_write_addtid_b32 v207 offset:43952
    ds_write_addtid_b32 v208 offset:44224
    ds_write_addtid_b32 v209 offset:44496
    ds_write_addtid_b32 v210 offset:44768
    ds_write_addtid_b32 v211 offset:45040
    ds_write_addtid_b32 v212 offset:45312
    ds_write_addtid_b32 v213 offset:45584
    ds_write_addtid_b32 v214 offset:45856
    ds_write_addtid_b32 v215 offset:46128
    ds_write_addtid_b32 v216 offset:46400
    ds_write_addtid_b32 v217 offset:46672
    ds_write_addtid_b32 v218 offset:46944
    ds_write_addtid_b32 v219 offset:47216
    ds_write_addtid_b32 v220 offset:47488
    ds_write_addtid_b32 v221 offset:47760
    ds_write_addtid_b32 v222 offset:48032
    ds_write_addtid_b32 v223 offset:48304
    ds_write_addtid_b32 v224 offset:48576
    ds_write_addtid_b32 v225 offset:48848
    ds_write_addtid_b32 v226 offset:49120
    ds_write_addtid_b32 v227 offset:49392
    ds_read_b128 v[144:147], v33 offset:40960
    ds_read_b128 v[148:151], v33 offset:40992
    ds_read_b128 v[152:155], v33 offset:41024
    ds_read_b128 v[156:159], v33 offset:41056
    ds_read_b128 v[160:163], v33 offset:41088
    ds_read_b128 v[164:167], v33 offset:41120
    ds_read_b128 v[168:171], v33 offset:41152
    ds_read_b128 v[172:175], v33 offset:41184
    s_waitcnt lgkmcnt(0)
    s_mov_b32 s58, 0
SH_lw:
    ds_read_b32 v12, v9 offset:40272
    s_add_u32 s58, s58, 1
    s_cmp_gt_u32 s58, 4194304
    s_cbranch_scc1 SH_lwok
    s_waitcnt lgkmcnt(0)
    v_cmp_gt_u32 vcc, 4, v12
    s_nop 0
    s_cbranch_vccz SH_lwok
    s_sleep 1
    s_branch SH_lw
SH_lwok:
    s_waitcnt lgkmcnt(0)
    s_mov_b64 exec, 1
    ds_add_u32 v9, v5 offset:40276
    s_mov_b64 exec, -1
    s_lshl_b32 s32, s28, 2
    v_mov_b32 v7, s32
    v_mfma_f32_32x32x16_bf16 v[16:31], v[44:47], v[76:79], 0
    s_mov_b32 m0, s74
    s_xor_b32 s32, s65, s75
    s_add_u32 s74, s74, 1024
    s_lshl_b32 s32, s32, 14
    s_add_u32 s65, s65, 1
    buffer_load_dwordx4 v8, s[44:47], s32 offen lds
    v_mfma_f32_32x32x16_bf16 v[16:31], v[48:51], v[80:83], v[16:31]
    s_mov_b32 m0, s74
    s_xor_b32 s32, s65, s75
    s_add_u32 s74, s74, 1024
    s_lshl_b32 s32, s32, 14
    s_add_u32 s65, s65, 1
    buffer_load_dwordx4 v8, s[44:47], s32 offen lds
    v_mfma_f32_32x32x16_bf16 v[16:31], v[52:55], v[84:87], v[16:31]
    s_mov_b32 m0, s74
    s_xor_b32 s32, s65, s75
    s_add_u32 s74, s74, 1024
    s_lshl_b32 s32, s32, 14
    s_add_u32 s65, s65, 1
    buffer_load_dwordx4 v8, s[44:47], s32 offen lds
    v_mfma_f32_32x32x16_bf16 v[16:31], v[56:59], v[88:91], v[16:31]
    s_mov_b32 m0, s74
    s_xor_b32 s32, s65, s75
    s_add_u32 s74, s74, 1024
    s_lshl_b32 s32, s32, 14
    s_add_u32 s65, s65, 1
    buffer_load_dwordx4 v8, s[44:47], s32 offen lds
    v_mfma_f32_32x32x16_bf16 v[16:31], v[60:63], v[92:95], v[16:31]
    s_add_u32 s32, s28, 80
    s_lshl_b32 s33, s32, 10
    s_add_u32 m0, s33, 40960
    s_xor_b32 s32, s32, s75
    s_lshl_b32 s32, s32, 14
    buffer_load_dwordx4 v8, s[44:47], s32 offen lds
    v_mfma_f32_32x32x16_bf16 v[16:31], v[64:67], v[96:99], v[16:31]
    s_add_u32 s32, s28, 84
    s_lshl_b32 s33, s32, 10
    s_add_u32 m0, s33, 40960
    s_xor_b32 s32, s32, s75
    s_lshl_b32 s32, s32, 14
    buffer_load_dwordx4 v8, s[44:47], s32 offen lds
    v_mfma_f32_32x32x16_bf16 v[16:31], v[68:71], v[100:103], v[16:31]
    s_add_u32 s32, s28, 88
    s_lshl_b32 s33, s32, 10
    s_add_u32 m0, s33, 40960
    s_xor_b32 s32, s32, s75
    s_lshl_b32 s32, s32, 14
    buffer_load_dwordx4 v8, s[44:47], s32 offen lds
    v_mfma_f32_32x32x16_bf16 v[16:31], v[72:75], v[104:107], v[16:31]
    s_add_u32 s32, s28, 92
    s_lshl_b32 s33, s32, 10
    s_add_u32 m0, s33, 40960
    s_xor_b32 s32, s32, s75
    s_lshl_b32 s32, s32, 14
    buffer_load_dwordx4 v8, s[44:47], s32 offen lds
    v_mfma_f32_32x32x16_bf16 v[16:31], v[112:115], v[144:147], v[16:31]
    ds_read_b128 v[220:223], v4 offset:14336
    v_mfma_f32_32x32x16_bf16 v[16:31], v[116:119], v[148:151], v[16:31]
    ds_read_b128 v[216:219], v4 offset:12288
    v_mfma_f32_32x32x16_bf16 v[16:31], v[120:123], v[152:155], v[16:31]
    ds_read_b128 v[212:215], v4 offset:10240
    v_mfma_f32_32x32x16_bf16 v[16:31], v[124:127], v[156:159], v[16:31]
    ds_read_b128 v[208:211], v4 offset:8192
    v_mfma_f32_32x32x16_bf16 v[16:31], v[128:131], v[160:163], v[16:31]
    ds_read_b128 v[204:207], v4 offset:6144
    v_mfma_f32_32x32x16_bf16 v[16:31], v[132:135], v[164:167], v[16:31]
    ds_read_b128 v[200:203], v4 offset:4096
    v_mfma_f32_32x32x16_bf16 v[16:31], v[136:139], v[168:171], v[16:31]
    ds_read_b128 v[196:199], v4 offset:2048
    v_mfma_f32_32x32x16_bf16 v[16:31], v[140:143], v[172:175], v[16:31]
    ds_read_b128 v[192:195], v4 offset:0
    s_mov_b32 s59, 0
    s_nop 9
    v_add_f32 v16, v16, v43
    v_cvt_pk_bf16_f32 v45, v18, v19
    v_cvt_pk_bf16_f32 v44, v16, v17
    ds_write_b64 v39, v[44:45] offset:64
    ds_read_b64_tr_b16 v[224:225], v3 offset:32
    ds_read_b64_tr_b16 v[226:227], v3 offset:0
    v_cvt_pk_bf16_f32 v46, v20, v20
    v_cvt_pk_bf16_f32 v47, v21, v22
    ds_write_b64 v39, v[46:47] offset:576
    ds_read_b64_tr_b16 v[228:229], v3 offset:544
    ds_read_b64_tr_b16 v[230:231], v3 offset:512
    v_cvt_pk_bf16_f32 v48, v23, v23
    v_cvt_pk_bf16_f32 v49, v23, v24
    v_cvt_pk_bf16_f32 v50, v24, v24
    v_cvt_pk_bf16_f32 v51, v25, v25
    ds_write_b128 v38, v[48:51] offset:1088
    s_waitcnt lgkmcnt(4)
    v_mfma_f32_32x32x16_bf16 v[176:191], v[220:223], v[224:227], 0
    ds_read_b64_tr_b16 v[232:233], v3 offset:1056
    ds_read_b64_tr_b16 v[234:235], v3 offset:1024
    ds_read_b64_tr_b16 v[236:237], v3 offset:1568
    ds_read_b64_tr_b16 v[238:239], v3 offset:1536
    v_cndmask_b32 v40, v27, v26, s[80:81]
    v_mfma_f32_32x32x16_bf16 v[160:175], v[216:219], v[224:227], 0
    v_cndmask_b32 v41, v29, v28, s[80:81]
    v_cvt_pk_bf16_f32 v52, v26, v26
    v_cvt_pk_bf16_f32 v53, v26, v26
    v_cvt_pk_bf16_f32 v54, v40, v27
    v_cvt_pk_bf16_f32 v55, v27, v27
    v_mfma_f32_32x32x16_bf16 v[144:159], v[212:215], v[224:227], 0
    ds_write_b128 v38, v[52:55] offset:2112
    ds_read_b64_tr_b16 v[240:241], v3 offset:2080
    ds_read_b64_tr_b16 v[242:243], v3 offset:2048
    ds_read_b64_tr_b16 v[244:245], v3 offset:2592
    ds_read_b64_tr_b16 v[246:247], v3 offset:2560
    v_mfma_f32_32x32x16_bf16 v[128:143], v[208:211], v[224:227], 0
    v_cvt_pk_bf16_f32 v56, v28, v28
    v_cvt_pk_bf16_f32 v57, v28, v28
    v_cvt_pk_bf16_f32 v58, v41, v29
    v_cvt_pk_bf16_f32 v59, v29, v29
    ds_write_b128 v38, v[56:59] offset:3136
    v_mfma_f32_32x32x16_bf16 v[112:127], v[204:207], v[224:227], 0
    ds_read_b64_tr_b16 v[248:249], v3 offset:3104
    ds_read_b64_tr_b16 v[250:251], v3 offset:3072
    ds_read_b64_tr_b16 v[252:253], v3 offset:3616
    ds_read_b64_tr_b16 v[254:255], v3 offset:3584
    v_mfma_f32_32x32x16_bf16 v[96:111], v[200:203], v[224:227], 0
    v_subrev_u32 v4, 512, v4
    v_add_u32 v3, 128, v3
    v_xor_b32 v4, 32, v4
    v_mfma_f32_32x32x16_bf16 v[80:95], v[196:199], v[224:227], 0
    v_mfma_f32_32x32x16_bf16 v[64:79], v[192:195], v[224:227], 0
    s_waitcnt lgkmcnt(0)
    s_branch S_conv1
S_conv:
    s_cmp_eq_u32 s59, 1
    s_cbranch_scc0 S_nosig
    s_waitcnt vmcnt(0)
    s_mov_b64 exec, 1
    ds_add_u32 v9, v5 offset:40236
    s_mov_b64 exec, -1
S_nosig:
    v_subrev_u32 v4, 512, v4
    v_add_u32 v3, 128, v3
    v_xor_b32 v4, 32, v4
    s_waitcnt lgkmcnt(15)
    v_mfma_f32_32x32x16_bf16 v[176:191], v[220:223], v[224:227], v[176:191]
    v_mfma_f32_32x32x16_bf16 v[160:175], v[216:219], v[224:227], v[160:175]
    s_waitcnt lgkmcnt(15)
    v_mfma_f32_32x32x16_bf16 v[144:159], v[212:215], v[224:227], v[144:159]
    s_waitcnt lgkmcnt(12)
    v_mfma_f32_32x32x16_bf16 v[128:143], v[208:211], v[224:227], v[128:143]
    s_waitcnt lgkmcnt(9)
    v_mfma_f32_32x32x16_bf16 v[112:127], v[204:207], v[224:227], v[112:127]
    s_waitcnt lgkmcnt(6)
    v_mfma_f32_32x32x16_bf16 v[96:111], v[200:203], v[224:227], v[96:111]
    s_waitcnt lgkmcnt(3)
    v_mfma_f32_32x32x16_bf16 v[80:95], v[196:199], v[224:227], v[80:95]
    s_waitcnt lgkmcnt(0)
    v_mfma_f32_32x32x16_bf16 v[64:79], v[192:195], v[224:227], v[64:79]
S_conv1:
    ds_read_b128 v[220:223], v4 offset:14336
    ds_read_b64_tr_b16 v[224:225], v3 offset:32
    ds_read_b64_tr_b16 v[226:227], v3 offset:0
    v_mfma_f32_32x32x16_bf16 v[176:191], v[216:219], v[228:231], v[176:191]
    v_mfma_f32_32x32x16_bf16 v[160:175], v[212:215], v[228:231], v[160:175]
    v_mfma_f32_32x32x16_bf16 v[144:159], v[208:211], v[228:231], v[144:159]
    v_mfma_f32_32x32x16_bf16 v[128:143], v[204:207], v[228:231], v[128:143]
    v_mfma_f32_32x32x16_bf16 v[112:127], v[200:203], v[228:231], v[112:127]
    v_mfma_f32_32x32x16_bf16 v[96:111], v[196:199], v[228:231], v[96:111]
    v_mfma_f32_32x32x16_bf16 v[80:95], v[192:195], v[228:231], v[80:95]
    ds_read_b128 v[216:219], v4 offset:12288
    ds_read_b64_tr_b16 v[228:229], v3 offset:544
    ds_read_b64_tr_b16 v[230:231], v3 offset:512
    v_mfma_f32_32x32x16_bf16 v[176:191], v[212:215], v[232:235], v[176:191]
    v_mfma_f32_32x32x16_bf16 v[160:175], v[208:211], v[232:235], v[160:175]
    v_mfma_f32_32x32x16_bf16 v[144:159], v[204:207], v[232:235], v[144:159]
    v_mfma_f32_32x32x16_bf16 v[128:143], v[200:203], v[232:235], v[128:143]
    v_mfma_f32_32x32x16_bf16 v[112:127], v[196:199], v[232:235], v[112:127]
    v_mfma_f32_32x32x16_bf16 v[96:111], v[192:195], v[232:235], v[96:111]
    ds_read_b128 v[212:215], v4 offset:10240
    ds_read_b64_tr_b16 v[232:233], v3 offset:1056
    ds_read_b64_tr_b16 v[234:235], v3 offset:1024
    v_mfma_f32_32x32x16_bf16 v[176:191], v[208:211], v[236:239], v[176:191]
    v_mfma_f32_32x32x16_bf16 v[160:175], v[204:207], v[236:239], v[160:175]
    v_mfma_f32_32x32x16_bf16 v[144:159], v[200:203], v[236:239], v[144:159]
    v_mfma_f32_32x32x16_bf16 v[128:143], v[196:199], v[236:239], v[128:143]
    v_mfma_f32_32x32x16_bf16 v[112:127], v[192:195], v[236:239], v[112:127]
    ds_read_b128 v[208:211], v4 offset:8192
    ds_read_b64_tr_b16 v[236:237], v3 offset:1568
    ds_read_b64_tr_b16 v[238:239], v3 offset:1536
    v_mfma_f32_32x32x16_bf16 v[176:191], v[204:207], v[240:243], v[176:191]
    v_mfma_f32_32x32x16_bf16 v[160:175], v[200:203], v[240:243], v[160:175]
    v_mfma_f32_32x32x16_bf16 v[144:159], v[196:199], v[240:243], v[144:159]
    v_mfma_f32_32x32x16_bf16 v[128:143], v[192:195], v[240:243], v[128:143]
    ds_read_b128 v[204:207], v4 offset:6144
    ds_read_b64_tr_b16 v[240:241], v3 offset:2080
    ds_read_b64_tr_b16 v[242:243], v3 offset:2048
    v_mfma_f32_32x32x16_bf16 v[176:191], v[200:203], v[244:247], v[176:191]
    v_mfma_f32_32x32x16_bf16 v[160:175], v[196:199], v[244:247], v[160:175]
    v_mfma_f32_32x32x16_bf16 v[144:159], v[192:195], v[244:247], v[144:159]
    ds_read_b128 v[200:203], v4 offset:4096
    ds_read_b64_tr_b16 v[244:245], v3 offset:2592
    ds_read_b64_tr_b16 v[246:247], v3 offset:2560
    v_mfma_f32_32x32x16_bf16 v[176:191], v[196:199], v[248:251], v[176:191]
    v_mfma_f32_32x32x16_bf16 v[160:175], v[192:195], v[248:251], v[160:175]
    ds_read_b128 v[196:199], v4 offset:2048
    ds_read_b64_tr_b16 v[248:249], v3 offset:3104
    ds_read_b64_tr_b16 v[250:251], v3 offset:3072
    v_mfma_f32_32x32x16_bf16 v[176:191], v[192:195], v[252:255], v[176:191]
    ds_read_b128 v[192:195], v4 offset:0
    ds_read_b64_tr_b16 v[252:253], v3 offset:3616
    ds_read_b64_tr_b16 v[254:255], v3 offset:3584
    s_add_u32 s59, s59, 1
    s_cmp_lt_u32 s59, 3
    s_cbranch_scc1 S_conv
    s_waitcnt lgkmcnt(15)
    v_mfma_f32_32x32x16_bf16 v[176:191], v[220:223], v[224:227], v[176:191]
    s_mov_b32 s60, 0
    s_mov_b32 s61, 0x80000000
    s_mov_b32 s80, 0
    s_mov_b32 s81, 0xc0000000
    s_waitcnt lgkmcnt(15)
    v_mfma_f32_32x32x16_bf16 v[176:191], v[216:219], v[228:231], v[176:191]
    s_mov_b32 s86, 0
    s_mov_b32 s87, 0xe0000000
    v_lshrrev_b32 v2, 2, v1
    v_and_b32 v6, 3, v1
    s_waitcnt lgkmcnt(15)
    v_mfma_f32_32x32x16_bf16 v[176:191], v[212:215], v[232:235], v[176:191]
    v_lshlrev_b32 v6, 4, v6
    v_lshl_add_u32 v2, v2, 12, v6
    s_lshl_b32 s32, s27, 18
    s_lshl_b32 s33, s68, 6
    s_waitcnt lgkmcnt(12)
    v_mfma_f32_32x32x16_bf16 v[176:191], v[208:211], v[236:239], v[176:191]
    s_add_u32 s32, s32, s33
    s_add_u32 s88, s32, 0
    s_waitcnt lgkmcnt(0)
    ds_read_b32 v6, v9 offset:40244
    v_mfma_f32_32x32x16_bf16 v[64:79], v[192:195], v[224:227], v[64:79]
    s_sub_u32 s65, s65, 8
    s_mov_b32 s74, s69
    s_mov_b32 m0, s74
    s_xor_b32 s32, s65, s75
    s_add_u32 s74, s74, 1024
    s_lshl_b32 s32, s32, 14
    s_add_u32 s65, s65, 1
    buffer_load_dwordx4 v8, s[44:47], s32 offen lds
    v_mfma_f32_32x32x16_bf16 v[80:95], v[196:199], v[224:227], v[80:95]
    s_mov_b32 m0, s74
    s_xor_b32 s32, s65, s75
    s_add_u32 s74, s74, 1024
    s_lshl_b32 s32, s32, 14
    s_add_u32 s65, s65, 1
    buffer_load_dwordx4 v8, s[44:47], s32 offen lds
    v_mfma_f32_32x32x16_bf16 v[80:95], v[192:195], v[228:231], v[80:95]
    s_mov_b32 m0, s74
    s_xor_b32 s32, s65, s75
    s_add_u32 s74, s74, 1024
    s_lshl_b32 s32, s32, 14
    s_add_u32 s65, s65, 1
    buffer_load_dwordx4 v8, s[44:47], s32 offen lds
    v_cndmask_b32 v38, v67, 0, s[86:87]
    v_cndmask_b32 v41, v71, v67, s[86:87]
    v_cndmask_b32 v44, v75, v71, s[86:87]
    v_cndmask_b32 v47, v79, v75, s[86:87]
    v_cndmask_b32 v37, v66, 0, s[80:81]
    s_waitcnt lgkmcnt(0)
    v_cmp_gt_u32 vcc, 4, v6
    s_nop 0
    s_cbranch_vccnz SK_slow
SK_back:
    s_setprio 2
    v_mfma_f32_32x32x16_bf16 v[96:111], v[200:203], v[224:227], v[96:111]
    s_mov_b32 m0, s74
    s_xor_b32 s32, s65, s75
    s_add_u32 s74, s74, 1024
    s_lshl_b32 s32, s32, 14
    s_add_u32 s65, s65, 1
    buffer_load_dwordx4 v8, s[44:47], s32 offen lds
    v_cndmask_b32 v40, v70, v66, s[80:81]
    v_cndmask_b32 v43, v74, v70, s[80:81]
    v_cndmask_b32 v46, v78, v74, s[80:81]
    v_cndmask_b32 v36, v65, 0, s[60:61]
    v_cndmask_b32 v39, v69, v65, s[60:61]
    v_mfma_f32_32x32x16_bf16 v[96:111], v[196:199], v[228:231], v[96:111]
    v_cndmask_b32 v42, v73, v69, s[60:61]
    v_cndmask_b32 v45, v77, v73, s[60:61]
    v_add_f32_dpp v37, v38, v37 wave_ror:1 row_mask:0xf bank_mask:0xf
    v_add_f32_dpp v40, v41, v40 wave_ror:1 row_mask:0xf bank_mask:0xf
    v_add_f32_dpp v43, v44, v43 wave_ror:1 row_mask:0xf bank_mask:0xf
    v_mfma_f32_32x32x16_bf16 v[96:111], v[192:195], v[232:235], v[96:111]
    v_add_f32_dpp v46, v47, v46 wave_ror:1 row_mask:0xf bank_mask:0xf
    v_add_f32_dpp v36, v37, v36 wave_ror:1 row_mask:0xf bank_mask:0xf
    v_add_f32_dpp v39, v40, v39 wave_ror:1 row_mask:0xf bank_mask:0xf
    v_add_f32_dpp v42, v43, v42 wave_ror:1 row_mask:0xf bank_mask:0xf
    v_add_f32_dpp v45, v46, v45 wave_ror:1 row_mask:0xf bank_mask:0xf
    v_mfma_f32_32x32x16_bf16 v[112:127], v[204:207], v[224:227], v[112:127]
    v_add_f32_dpp v64, v36, v64 wave_ror:1 row_mask:0xf bank_mask:0xf
    v_add_f32_dpp v68, v39, v68 wave_ror:1 row_mask:0xf bank_mask:0xf
    v_add_f32_dpp v72, v42, v72 wave_ror:1 row_mask:0xf bank_mask:0xf
    v_add_f32_dpp v76, v45, v76 wave_ror:1 row_mask:0xf bank_mask:0xf
    v_cvt_pk_bf16_f32 v16, v64, v68
    v_mfma_f32_32x32x16_bf16 v[112:127], v[200:203], v[228:231], v[112:127]
    v_cvt_pk_bf16_f32 v17, v72, v76
    v_cndmask_b32 v38, v83, v79, s[86:87]
    v_cndmask_b32 v41, v87, v83, s[86:87]
    v_cndmask_b32 v44, v91, v87, s[86:87]
    v_cndmask_b32 v47, v95, v91, s[86:87]
    v_mfma_f32_32x32x16_bf16 v[112:127], v[196:199], v[232:235], v[112:127]
    v_cndmask_b32 v37, v82, v78, s[80:81]
    v_cndmask_b32 v40, v86, v82, s[80:81]
    v_cndmask_b32 v43, v90, v86, s[80:81]
    v_cndmask_b32 v46, v94, v90, s[80:81]
    v_cndmask_b32 v36, v81, v77, s[60:61]
    v_mfma_f32_32x32x16_bf16 v[112:127], v[192:195], v[236:239], v[112:127]
    v_cndmask_b32 v39, v85, v81, s[60:61]
    v_cndmask_b32 v42, v89, v85, s[60:61]
    v_cndmask_b32 v45, v93, v89, s[60:61]
    v_add_f32_dpp v37, v38, v37 wave_ror:1 row_mask:0xf bank_mask:0xf
    v_add_f32_dpp v40, v41, v40 wave_ror:1 row_mask:0xf bank_mask:0xf
    v_mfma_f32_32x32x16_bf16 v[128:143], v[208:211], v[224:227], v[128:143]
    v_add_f32_dpp v43, v44, v43 wave_ror:1 row_mask:0xf bank_mask:0xf
    v_add_f32_dpp v46, v47, v46 wave_ror:1 row_mask:0xf bank_mask:0xf
    v_add_f32_dpp v36, v37, v36 wave_ror:1 row_mask:0xf bank_mask:0xf
    v_add_f32_dpp v39, v40, v39 wave_ror:1 row_mask:0xf bank_mask:0xf
    v_add_f32_dpp v42, v43, v42 wave_ror:1 row_mask:0xf bank_mask:0xf
    v_mfma_f32_32x32x16_bf16 v[128:143], v[204:207], v[228:231], v[128:143]
    v_add_f32_dpp v45, v46, v45 wave_ror:1 row_mask:0xf bank_mask:0xf
    v_add_f32_dpp v80, v36, v80 wave_ror:1 row_mask:0xf bank_mask:0xf
    v_add_f32_dpp v84, v39, v84 wave_ror:1 row_mask:0xf bank_mask:0xf
    v_add_f32_dpp v88, v42, v88 wave_ror:1 row_mask:0xf bank_mask:0xf
    v_add_f32_dpp v92, v45, v92 wave_ror:1 row_mask:0xf bank_mask:0xf
    v_mfma_f32_32x32x16_bf16 v[128:143], v[200:203], v[232:235], v[128:143]
    v_cvt_pk_bf16_f32 v18, v80, v84
    v_cvt_pk_bf16_f32 v19, v88, v92
    s_cmp_eq_u32 s49, 0
    s_cbranch_scc1 X3_slow
    buffer_store_dwordx4 v[16:19], v2, s[40:43], s88 offen nt
X3_back:
    s_add_u32 s88, s88, 65536
    v_cndmask_b32 v38, v99, v95, s[86:87]
    v_cndmask_b32 v41, v103, v99, s[86:87]
    v_mfma_f32_32x32x16_bf16 v[128:143], v[196:199], v[236:239], v[128:143]
    v_cndmask_b32 v44, v107, v103, s[86:87]
    v_cndmask_b32 v47, v111, v107, s[86:87]
    v_cndmask_b32 v37, v98, v94, s[80:81]
    v_cndmask_b32 v40, v102, v98, s[80:81]
    v_cndmask_b32 v43, v106, v102, s[80:81]
    v_mfma_f32_32x32x16_bf16 v[128:143], v[192:195], v[240:243], v[128:143]
    v_cndmask_b32 v46, v110, v106, s[80:81]
    v_cndmask_b32 v36, v97, v93, s[60:61]
    v_cndmask_b32 v39, v101, v97, s[60:61]
    v_cndmask_b32 v42, v105, v101, s[60:61]
    v_cndmask_b32 v45, v109, v105, s[60:61]
    v_mfma_f32_32x32x16_bf16 v[144:159], v[212:215], v[224:227], v[144:159]
    v_add_f32_dpp v37, v38, v37 wave_ror:1 row_mask:0xf bank_mask:0xf
    v_add_f32_dpp v40, v41, v40 wave_ror:1 row_mask:0xf bank_mask:0xf
    v_add_f32_dpp v43, v44, v43 wave_ror:1 row_mask:0xf bank_mask:0xf
    v_add_f32_dpp v46, v47, v46 wave_ror:1 row_mask:0xf bank_mask:0xf
    v_add_f32_dpp v36, v37, v36 wave_ror:1 row_mask:0xf bank_mask:0xf
    v_mfma_f32_32x32x16_bf16 v[144:159], v[208:211], v[228:231], v[144:159]
    v_add_f32_dpp v39, v40, v39 wave_ror:1 row_mask:0xf bank_mask:0xf
    v_add_f32_dpp v42, v43, v42 wave_ror:1 row_mask:0xf bank_mask:0xf
    v_add_f32_dpp v45, v46, v45 wave_ror:1 row_mask:0xf bank_mask:0xf
    v_add_f32_dpp v96, v36, v96 wave_ror:1 row_mask:0xf bank_mask:0xf
    v_add_f32_dpp v100, v39, v100 wave_ror:1 row_mask:0xf bank_mask:0xf
    v_mfma_f32_32x32x16_bf16 v[144:159], v[204:207], v[232:235], v[144:159]
    v_add_f32_dpp v104, v42, v104 wave_ror:1 row_mask:0xf bank_mask:0xf
    v_add_f32_dpp v108, v45, v108 wave_ror:1 row_mask:0xf bank_mask:0xf
    v_cvt_pk_bf16_f32 v20, v96, v100
    v_cvt_pk_bf16_f32 v21, v104, v108
    v_cndmask_b32 v38, v115, v111, s[86:87]
    v_mfma_f32_32x32x16_bf16 v[144:159], v[200:203], v[236:239], v[144:159]
    v_cndmask_b32 v41, v119, v115, s[86:87]
    v_cndmask_b32 v44, v123, v119, s[86:87]
    v_cndmask_b32 v47, v127, v123, s[86:87]
    v_cndmask_b32 v37, v114, v110, s[80:81]
    v_cndmask_b32 v40, v118, v114, s[80:81]
    v_mfma_f32_32x32x16_bf16 v[144:159], v[196:199], v[240:243], v[144:159]
    v_cndmask_b32 v43, v122, v118, s[80:81]
    v_cndmask_b32 v46, v126, v122, s[80:81]
    v_cndmask_b32 v36, v113, v109, s[60:61]
    v_cndmask_b32 v39, v117, v113, s[60:61]
    v_cndmask_b32 v42, v121, v117, s[60:61]
    v_mfma_f32_32x32x16_bf16 v[144:159], v[192:195], v[244:247], v[144:159]
    v_cndmask_b32 v45, v125, v121, s[60:61]
    v_add_f32_dpp v37, v38, v37 wave_ror:1 row_mask:0xf bank_mask:0xf
    v_add_f32_dpp v40, v41, v40 wave_ror:1 row_mask:0xf bank_mask:0xf
    v_add_f32_dpp v43, v44, v43 wave_ror:1 row_mask:0xf bank_mask:0xf
    v_add_f32_dpp v46, v47, v46 wave_ror:1 row_mask:0xf bank_mask:0xf
    v_mfma_f32_32x32x16_bf16 v[160:175], v[216:219], v[224:227], v[160:175]
    v_add_f32_dpp v36, v37, v36 wave_ror:1 row_mask:0xf bank_mask:0xf
    v_add_f32_dpp v39, v40, v39 wave_ror:1 row_mask:0xf bank_mask:0xf
    v_add_f32_dpp v42, v43, v42 wave_ror:1 row_mask:0xf bank_mask:0xf
    v_add_f32_dpp v45, v46, v45 wave_ror:1 row_mask:0xf bank_mask:0xf
    v_add_f32_dpp v112, v36, v112 wave_ror:1 row_mask:0xf bank_mask:0xf
    v_mfma_f32_32x32x16_bf16 v[160:175], v[212:215], v[228:231], v[160:175]
    v_add_f32_dpp v116, v39, v116 wave_ror:1 row_mask:0xf bank_mask:0xf
    v_add_f32_dpp v120, v42, v120 wave_ror:1 row_mask:0xf bank_mask:0xf
    v_add_f32_dpp v124, v45, v124 wave_ror:1 row_mask:0xf bank_mask:0xf
    v_cvt_pk_bf16_f32 v22, v112, v116
    v_cvt_pk_bf16_f32 v23, v120, v124
    v_mfma_f32_32x32x16_bf16 v[160:175], v[208:211], v[232:235], v[160:175]
    s_cmp_eq_u32 s49, 0
    s_cbranch_scc1 X4_slow
    buffer_store_dwordx4 v[20:23], v2, s[40:43], s88 offen nt
X4_back:
    s_add_u32 s88, s88, 65536
    v_cndmask_b32 v38, v131, v127, s[86:87]
    v_cndmask_b32 v41, v135, v131, s[86:87]
    v_cndmask_b32 v44, v139, v135, s[86:87]
    v_cndmask_b32 v47, v143, v139, s[86:87]
    v_mfma_f32_32x32x16_bf16 v[160:175], v[204:207], v[236:239], v[160:175]
    v_cndmask_b32 v37, v130, v126, s[80:81]
    v_cndmask_b32 v40, v134, v130, s[80:81]
    v_cndmask_b32 v43, v138, v134, s[80:81]
    v_cndmask_b32 v46, v142, v138, s[80:81]
    v_cndmask_b32 v36, v129, v125, s[60:61]
    v_mfma_f32_32x32x16_bf16 v[160:175], v[200:203], v[240:243], v[160:175]
    v_cndmask_b32 v39, v133, v129, s[60:61]
    v_cndmask_b32 v42, v137, v133, s[60:61]
    v_cndmask_b32 v45, v141, v137, s[60:61]
    v_add_f32_dpp v37, v38, v37 wave_ror:1 row_mask:0xf bank_mask:0xf
    v_add_f32_dpp v40, v41, v40 wave_ror:1 row_mask:0xf bank_mask:0xf
    v_mfma_f32_32x32x16_bf16 v[160:175], v[196:199], v[244:247], v[160:175]
    v_add_f32_dpp v43, v44, v43 wave_ror:1 row_mask:0xf bank_mask:0xf
    v_add_f32_dpp v46, v47, v46 wave_ror:1 row_mask:0xf bank_mask:0xf
    v_add_f32_dpp v36, v37, v36 wave_ror:1 row_mask:0xf bank_mask:0xf
    v_add_f32_dpp v39, v40, v39 wave_ror:1 row_mask:0xf bank_mask:0xf
    v_add_f32_dpp v42, v43, v42 wave_ror:1 row_mask:0xf bank_mask:0xf
    v_mfma_f32_32x32x16_bf16 v[160:175], v[192:195], v[248:251], v[160:175]
    v_add_f32_dpp v45, v46, v45 wave_ror:1 row_mask:0xf bank_mask:0xf
    v_add_f32_dpp v128, v36, v128 wave_ror:1 row_mask:0xf bank_mask:0xf
    v_add_f32_dpp v132, v39, v132 wave_ror:1 row_mask:0xf bank_mask:0xf
    v_add_f32_dpp v136, v42, v136 wave_ror:1 row_mask:0xf bank_mask:0xf
    v_add_f32_dpp v140, v45, v140 wave_ror:1 row_mask:0xf bank_mask:0xf
    v_mfma_f32_32x32x16_bf16 v[176:191], v[204:207], v[240:243], v[176:191]
    v_cvt_pk_bf16_f32 v24, v128, v132
    v_cvt_pk_bf16_f32 v25, v136, v140
    v_cndmask_b32 v38, v147, v143, s[86:87]
    v_cndmask_b32 v41, v151, v147, s[86:87]
    v_cndmask_b32 v44, v155, v151, s[86:87]
    v_mfma_f32_32x32x16_bf16 v[176:191], v[200:203], v[244:247], v[176:191]
    v_cndmask_b32 v47, v159, v155, s[86:87]
    v_cndmask_b32 v37, v146, v142, s[80:81]
    v_cndmask_b32 v40, v150, v146, s[80:81]
    v_cndmask_b32 v43, v154, v150, s[80:81]
    v_cndmask_b32 v46, v158, v154, s[80:81]
    v_mfma_f32_32x32x16_bf16 v[176:191], v[196:199], v[248:251], v[176:191]
    v_cndmask_b32 v36, v145, v141, s[60:61]
    v_cndmask_b32 v39, v149, v145, s[60:61]
    v_cndmask_b32 v42, v153, v149, s[60:61]
    v_cndmask_b32 v45, v157, v153, s[60:61]
    v_add_f32_dpp v37, v38, v37 wave_ror:1 row_mask:0xf bank_mask:0xf
    v_mfma_f32_32x32x16_bf16 v[176:191], v[192:195], v[252:255], v[176:191]
    v_add_f32_dpp v40, v41, v40 wave_ror:1 row_mask:0xf bank_mask:0xf
    v_add_f32_dpp v43, v44, v43 wave_ror:1 row_mask:0xf bank_mask:0xf
    v_add_f32_dpp v46, v47, v46 wave_ror:1 row_mask:0xf bank_mask:0xf
    v_add_f32_dpp v36, v37, v36 wave_ror:1 row_mask:0xf bank_mask:0xf
    v_add_f32_dpp v39, v40, v39 wave_ror:1 row_mask:0xf bank_mask:0xf
    s_setprio 0
    v_add_f32_dpp v42, v43, v42 wave_ror:1 row_mask:0xf bank_mask:0xf
    v_add_f32_dpp v45, v46, v45 wave_ror:1 row_mask:0xf bank_mask:0xf
    v_add_f32_dpp v144, v36, v144 wave_ror:1 row_mask:0xf bank_mask:0xf
    v_add_f32_dpp v148, v39, v148 wave_ror:1 row_mask:0xf bank_mask:0xf
    v_add_f32_dpp v152, v42, v152 wave_ror:1 row_mask:0xf bank_mask:0xf
    v_add_f32_dpp v156, v45, v156 wave_ror:1 row_mask:0xf bank_mask:0xf
    v_cvt_pk_bf16_f32 v26, v144, v148
    v_cvt_pk_bf16_f32 v27, v152, v156
    s_cmp_eq_u32 s49, 0
    s_cbranch_scc1 X5_slow
    buffer_store_dwordx4 v[24:27], v2, s[40:43], s88 offen nt
X5_back:
    s_add_u32 s88, s88, 65536
    v_cndmask_b32 v38, v163, v159, s[86:87]
    v_cndmask_b32 v41, v167, v163, s[86:87]
    v_cndmask_b32 v44, v171, v167, s[86:87]
    v_cndmask_b32 v47, v175, v171, s[86:87]
    v_cndmask_b32 v37, v162, v158, s[80:81]
    v_cndmask_b32 v40, v166, v162, s[80:81]
    v_cndmask_b32 v43, v170, v166, s[80:81]
    v_cndmask_b32 v46, v174, v170, s[80:81]
    v_cndmask_b32 v36, v161, v157, s[60:61]
    v_cndmask_b32 v39, v165, v161, s[60:61]
    v_cndmask_b32 v42, v169, v165, s[60:61]
    v_cndmask_b32 v45, v173, v169, s[60:61]
    v_add_f32_dpp v37, v38, v37 wave_ror:1 row_mask:0xf bank_mask:0xf
    v_add_f32_dpp v40, v41, v40 wave_ror:1 row_mask:0xf bank_mask:0xf
    v_add_f32_dpp v43, v44, v43 wave_ror:1 row_mask:0xf bank_mask:0xf
    v_add_f32_dpp v46, v47, v46 wave_ror:1 row_mask:0xf bank_mask:0xf
    v_add_f32_dpp v36, v37, v36 wave_ror:1 row_mask:0xf bank_mask:0xf
    v_add_f32_dpp v39, v40, v39 wave_ror:1 row_mask:0xf bank_mask:0xf
    v_add_f32_dpp v42, v43, v42 wave_ror:1 row_mask:0xf bank_mask:0xf
    v_add_f32_dpp v45, v46, v45 wave_ror:1 row_mask:0xf bank_mask:0xf
    v_add_f32_dpp v160, v36, v160 wave_ror:1 row_mask:0xf bank_mask:0xf
    v_add_f32_dpp v164, v39, v164 wave_ror:1 row_mask:0xf bank_mask:0xf
    v_add_f32_dpp v168, v42, v168 wave_ror:1 row_mask:0xf bank_mask:0xf
    v_add_f32_dpp v172, v45, v172 wave_ror:1 row_mask:0xf bank_mask:0xf
    v_cvt_pk_bf16_f32 v28, v160, v164
    v_cvt_pk_bf16_f32 v29, v168, v172
    v_cndmask_b32 v38, v179, v175, s[86:87]
    v_cndmask_b32 v41, v183, v179, s[86:87]
    v_cndmask_b32 v44, v187, v183, s[86:87]
    v_cndmask_b32 v47, v191, v187, s[86:87]
    v_cndmask_b32 v37, v178, v174, s[80:81]
    v_cndmask_b32 v40, v182, v178, s[80:81]
    v_cndmask_b32 v43, v186, v182, s[80:81]
    v_cndmask_b32 v46, v190, v186, s[80:81]
    v_cndmask_b32 v36, v177, v173, s[60:61]
    v_cndmask_b32 v39, v181, v177, s[60:61]
    v_cndmask_b32 v42, v185, v181, s[60:61]
    v_cndmask_b32 v45, v189, v185, s[60:61]
    v_add_f32_dpp v37, v38, v37 wave_ror:1 row_mask:0xf bank_mask:0xf
    v_add_f32_dpp v40, v41, v40 wave_ror:1 row_mask:0xf bank_mask:0xf
    v_add_f32_dpp v43, v44, v43 wave_ror:1 row_mask:0xf bank_mask:0xf
    v_add_f32_dpp v46, v47, v46 wave_ror:1 row_mask:0xf bank_mask:0xf
    v_add_f32_dpp v36, v37, v36 wave_ror:1 row_mask:0xf bank_mask:0xf
    v_add_f32_dpp v39, v40, v39 wave_ror:1 row_mask:0xf bank_mask:0xf
    v_add_f32_dpp v42, v43, v42 wave_ror:1 row_mask:0xf bank_mask:0xf
    v_add_f32_dpp v45, v46, v45 wave_ror:1 row_mask:0xf bank_mask:0xf
    v_add_f32_dpp v176, v36, v176 wave_ror:1 row_mask:0xf bank_mask:0xf
    v_add_f32_dpp v180, v39, v180 wave_ror:1 row_mask:0xf bank_mask:0xf
    v_add_f32_dpp v184, v42, v184 wave_ror:1 row_mask:0xf bank_mask:0xf
    v_add_f32_dpp v188, v45, v188 wave_ror:1 row_mask:0xf bank_mask:0xf
    v_cvt_pk_bf16_f32 v30, v176, v180
    v_cvt_pk_bf16_f32 v31, v184, v188
    s_cmp_eq_u32 s49, 0
    s_cbranch_scc1 X6_slow
    buffer_store_dwordx4 v[28:31], v2, s[40:43], s88 offen nt
X6_back:
    s_waitcnt vmcnt(0)
    s_mov_b64 exec, 1
    ds_add_rtn_u32 v12, v9, v5 offset:40232
    s_waitcnt lgkmcnt(0)
    v_readfirstlane_b32 s73, v12
    s_nop 0
    s_cmp_eq_u32 s73, 3
    s_cbranch_scc0 SY_arr
    s_cmp_eq_u32 s49, 0
    s_cbranch_scc1 X7_slow
    buffer_store_dwordx2 v[10:11], v9, s[40:43], s62 offen offset:256
X7_back:
SY_arr:
    s_mov_b64 exec, -1
    s_mov_b32 s76, s50
    s_mov_b32 s77, s51
    s_mov_b32 s78, 8388608
    s_mov_b32 s79, 0x20000
    s_mul_i32 s89, s28, 4352
    s_add_u32 s89, s89, 145408
    v_and_b32 v6, 7, v1
    v_lshrrev_b32 v7, 1, v6
    v_lshlrev_b32 v7, 6, v7
    v_lshl_add_u32 v7, v6, 9, v7
    v_lshrrev_b32 v4, 3, v1
    v_lshl_add_u32 v7, v4, 3, v7
    v_add_u32 v7, s89, v7
    v_and_b32 v4, 1, v4
    v_lshlrev_b32 v4, 20, v4
    v_lshrrev_b32 v13, 4, v1
    v_lshl_add_u32 v4, v13, 12, v4
    v_lshl_add_u32 v4, v6, 4, v4
    s_lshl_b32 s32, s35, 7
    s_lshr_b32 s33, s26, 2
    s_lshl_b32 s33, s33, 21
    s_add_u32 s32, s32, s33
    s_and_b32 s33, s68, 15
    s_lshl_b32 s33, s33, 14
    s_add_u32 s32, s32, s33
    s_add_u32 s64, s32, 2048
    s_lshl_b32 s32, s28, 12
    s_add_u32 s32, s32, s3
    s_add_u32 s74, s32, 0
    s_mov_b32 s60, 0x05040100
    s_mov_b32 s61, 0x07060302
    s_cmp_eq_u32 s73, 3
    s_cbranch_scc0 SY_oth
    buffer_load_dwordx2 v[12:13], v14, s[40:43], s63 offen offset:256 sc1
    s_waitcnt vmcnt(0)
    v_cmp_ne_u64 vcc, v[12:13], v[10:11]
    s_mov_b64 exec, 1
    ds_add_u32 v9, v5 offset:40260
    s_mov_b64 exec, -1
    s_cbranch_vccz SY_rel
    s_mov_b32 s58, 0
SY_poll:
    buffer_load_dwordx2 v[12:13], v14, s[40:43], s63 offen offset:256 sc1
    s_add_u32 s58, s58, 1
    s_cmp_gt_u32 s58, 1048576
    s_cbranch_scc1 SY_pollok
    s_waitcnt vmcnt(0)
    v_cmp_ne_u64 vcc, v[12:13], v[10:11]
    s_nop 4
    s_cbranch_vccz SY_pollok
    s_sleep 2
    s_branch SY_poll
SY_pollok:
    s_waitcnt vmcnt(0)
SY_rel:
    ds_write_b32 v9, v5 offset:40252
    s_branch SY_go
SY_oth:
    s_waitcnt vmcnt(0)
    s_mov_b64 exec, 1
    ds_add_u32 v9, v5 offset:40260
    s_mov_b64 exec, -1
    s_mov_b32 s58, 0
SY_lw:
    ds_read_b32 v12, v9 offset:40252
    s_add_u32 s58, s58, 1
    s_cmp_gt_u32 s58, 4194304
    s_cbranch_scc1 SY_lwok
    s_waitcnt lgkmcnt(0)
    v_cmp_gt_u32 vcc, 1, v12
    s_nop 0
    s_cbranch_vccz SY_lwok
    s_sleep 1
    s_branch SY_lw
SY_lwok:
    s_waitcnt lgkmcnt(0)
SY_go:
    s_add_u32 m0, s89, 0
    s_nop 0
    buffer_load_dwordx4 v15, s[40:43], s74 offen offset:0 sc1 nt lds
    s_add_u32 m0, s89, 64
    s_nop 0
    buffer_load_dwordx4 v15, s[40:43], s74 offen offset:1024 sc1 nt lds
    s_add_u32 m0, s89, 128
    s_nop 0
    buffer_load_dwordx4 v15, s[40:43], s74 offen offset:2048 sc1 nt lds
    s_add_u32 m0, s89, 192
    s_nop 0
    buffer_load_dwordx4 v15, s[40:43], s74 offen offset:3072 sc1 nt lds
    s_waitcnt vmcnt(0)
    ds_read_b64 v[96:97], v7 offset:0
    ds_read_b64 v[98:99], v7 offset:64
    ds_read_b64 v[100:101], v7 offset:128
    ds_read_b64 v[102:103], v7 offset:192
    ds_read_b64 v[104:105], v7 offset:256
    ds_read_b64 v[106:107], v7 offset:320
    ds_read_b64 v[108:109], v7 offset:384
    ds_read_b64 v[110:111], v7 offset:448
    s_waitcnt lgkmcnt(0)
    v_perm_b32 v112, v98, v96, s60
    v_perm_b32 v113, v102, v100, s60
    v_perm_b32 v114, v106, v104, s60
    v_perm_b32 v115, v110, v108, s60
    buffer_store_dwordx4 v[112:115], v4, s[76:79], s64 offen nt
    s_add_u32 s64, s64, 262144
    v_perm_b32 v116, v98, v96, s61
    v_perm_b32 v117, v102, v100, s61
    v_perm_b32 v118, v106, v104, s61
    v_perm_b32 v119, v110, v108, s61
    buffer_store_dwordx4 v[116:119], v4, s[76:79], s64 offen nt
    s_add_u32 s64, s64, 262144
    v_perm_b32 v120, v99, v97, s60
    v_perm_b32 v121, v103, v101, s60
    v_perm_b32 v122, v107, v105, s60
    v_perm_b32 v123, v111, v109, s60
    buffer_store_dwordx4 v[120:123], v4, s[76:79], s64 offen nt
    s_add_u32 s64, s64, 262144
    v_perm_b32 v124, v99, v97, s61
    v_perm_b32 v125, v103, v101, s61
    v_perm_b32 v126, v107, v105, s61
    v_perm_b32 v127, v111, v109, s61
    buffer_store_dwordx4 v[124:127], v4, s[76:79], s64 offen nt
    s_endpgm
G_entry:
    v_mov_b32 v26, 0
    v_lshlrev_b32 v30, 4, v1
    s_lshr_b32 s32, s28, 1
    s_lshl_b32 s33, s27, 1
    s_add_u32 s73, s32, s33
    s_lshl_b32 s34, s32, 11
    s_add_u32 s34, s34, 34816
    s_and_b32 s70, s24, 3
    s_lshl_b32 s70, s70, 2
    s_and_b32 s72, s25, 3
    s_add_u32 s70, s70, s72
    s_lshr_b32 s71, s24, 2
    s_lshl_b32 s71, s71, 3
    s_lshr_b32 s32, s25, 2
    s_add_u32 s71, s71, s32
    s_add_u32 s72, s72, s32
    s_and_b32 s72, s72, 1
    s_lshl_b32 s72, s72, 2
    v_lshrrev_b32 v14, 5, v1
    v_bfe_u32 v15, v1, 2, 2
    v_lshl_add_u32 v14, v14, 3, v15
    v_bfe_u32 v16, v1, 4, 1
    v_lshlrev_b32 v16, 5, v16
    v_lshl_add_u32 v16, v14, 6, v16
    v_and_b32 v15, 3, v1
    v_lshl_add_u32 v31, v15, 3, v16
    v_add_u32 v17, s34, v31
    v_lshrrev_b32 v14, 1, v14
    v_lshlrev_b32 v14, 3, v14
    v_xor_b32 v14, v14, v31
    s_lshl_b32 s32, s28, 13
    s_and_b32 s33, s28, 1
    s_lshl_b32 s33, s33, 12
    s_add_u32 s32, s32, s33
    s_add_u32 s32, s32, 81920
    v_add_u32 v56, s32, v14
    v_xor_b32 v57, 16, v56
    v_and_b32 v14, 15, v1
    v_lshrrev_b32 v15, 4, v1
    v_bfe_u32 v16, v1, 1, 3
    v_xor_b32 v16, v15, v16
    v_lshlrev_b32 v16, 4, v16
    v_lshl_add_u32 v16, v14, 7, v16
    s_and_b32 s32, s28, 1
    s_lshl_b32 s32, s32, 13
    v_add_u32 v9, s32, v16
    v_xor_b32 v10, 64, v9
    v_and_b32 v16, 1, v15
    v_mul_u32_u24 v15, 3072, v15
    v_lshl_add_u32 v15, v16, 5, v15
    v_bfe_u32 v14, v1, 2, 2
    v_lshl_add_u32 v15, v14, 7, v15
    v_lshrrev_b32 v14, 1, v14
    s_lshr_b32 s32, s28, 1
    v_xor_b32 v14, s32, v14
    v_lshl_add_u32 v15, v14, 6, v15
    v_and_b32 v14, 3, v1
    v_lshl_add_u32 v12, v14, 3, v15
    v_xor_b32 v13, 32, v12
    v_add_u32 v9, 81920, v9
    v_add_u32 v10, 81920, v10
    v_add_u32 v12, 81920, v12
    v_add_u32 v13, 81920, v13
    v_lshlrev_b32 v51, 2, v1
    ds_write_b32 v51, v26 offset:40192
    v_mov_b32 v160, 0
    v_mov_b32 v161, 0
    v_mov_b32 v162, 0
    v_mov_b32 v163, 0
    s_nop 1
    v_mfma_f32_32x32x16_bf16 v[64:79], v[160:163], v[160:163], 0
    v_mfma_f32_32x32x16_bf16 v[80:95], v[160:163], v[160:163], 0
    v_mfma_f32_32x32x16_bf16 v[96:111], v[160:163], v[160:163], 0
    v_mfma_f32_32x32x16_bf16 v[112:127], v[160:163], v[160:163], 0
    v_mfma_f32_32x32x16_bf16 v[128:143], v[160:163], v[160:163], 0
    v_mfma_f32_32x32x16_bf16 v[144:159], v[160:163], v[160:163], 0
    v_and_b32 v14, 31, v1
    v_lshrrev_b32 v15, 5, v1
    v_bfe_u32 v16, v1, 1, 3
    v_xor_b32 v16, v15, v16
    v_lshlrev_b32 v16, 3, v16
    v_lshl_add_u32 v16, v14, 6, v16
    s_lshr_b32 s32, s28, 1
    s_lshl_b32 s32, s32, 14
    s_and_b32 s34, s28, 1
    s_lshl_b32 s33, s34, 12
    s_add_u32 s32, s32, s33
    s_add_u32 s32, s32, 81920
    v_add_u32 v52, s32, v16
    v_xor_b32 v53, 16, v52
    v_xor_b32 v54, 32, v52
    v_xor_b32 v55, 48, v52
    v_lshlrev_b32 v14, 2, v14
    v_lshl_add_u32 v58, v15, 17, v14
    v_and_b32 v16, 15, v1
    v_lshlrev_b32 v16, 4, v16
    v_lshl_add_u32 v16, v15, 9, v16
    v_bfe_u32 v14, v1, 4, 1
    v_lshl_add_u32 v16, v14, 3, v16
    s_lshl_b32 s32, s28, 12
    s_add_u32 s32, s32, 114688
    v_add_u32 v50, s32, v30
    s_xor_b32 s32, s28, 1
    s_lshl_b32 s32, s32, 12
    s_add_u32 s32, s32, 114688
    v_add_u32 v247, s32, v30
    s_and_b32 s32, s28, 2
    s_lshl_b32 s32, s32, 1
    v_mov_b32 v244, s32
    v_mov_b32 v245, 1
    v_lshrrev_b32 v14, 4, v1
    v_xor_b32 v14, v14, v1
    v_and_b32 v14, 1, v14
    v_subrev_u32 v14, 1, v14
    v_and_b32 v60, 0x3f803f80, v14
    v_mov_b32 v61, v60
    v_mov_b32 v62, v60
    v_mov_b32 v63, v60
    v_and_b32 v14, 15, v1
    v_lshlrev_b32 v248, 3, v14
    v_lshlrev_b32 v14, 4, v14
    v_bfe_u32 v16, v1, 4, 1
    v_lshl_add_u32 v14, v16, 10, v14
    v_lshl_add_u32 v59, v15, 8, v14
    v_and_b32 v14, 15, v1
    v_lshlrev_b32 v14, 14, v14
    v_lshl_add_u32 v242, v16, 3, v14
    v_lshlrev_b32 v246, 4, v15
    s_mov_b32 s56, 1069066811
    s_mov_b32 s57, 1069066811
    s_lshl_b32 s33, s28, 11
    s_add_u32 s33, s33, 0
    s_add_u32 s82, s3, s33
    s_lshl_b32 s32, s27, 18
    s_add_u32 s33, s33, s32
    s_lshl_b32 s60, s26, 7
    s_add_u32 s86, s33, s60
    s_lshl_b32 s33, s28, 7
    s_add_u32 s32, s32, s33
    s_and_b32 s33, s26, 2
    s_lshl_b32 s33, s33, 5
    s_add_u32 s32, s32, s33
    s_and_b32 s33, s26, 4
    s_lshl_b32 s33, s33, 3
    s_add_u32 s32, s32, s33
    s_and_b32 s33, s26, 1
    s_lshl_b32 s33, s33, 4
    s_add_u32 s32, s32, s33
    s_lshr_b32 s33, s26, 3
    s_lshl_b32 s33, s33, 2
    s_add_u32 s32, s32, s33
    s_add_u32 s87, s32, 8192
    s_lshl_b32 s32, s28, 7
    s_add_u32 s32, s32, s3
    s_add_u32 s83, s32, 8192
    s_lshl_b32 s32, s73, 12
    s_add_u32 s89, s32, 16777216
    s_lshl_b32 s32, s26, 1
    s_add_u32 s32, s32, s34
    s_lshl_b32 s32, s32, 17
    s_bfe_u32 s33, s73, 0x10003
    s_mul_i32 s33, s33, 4
    s_xor_b32 s33, s33, s73
    s_lshl_b32 s33, s33, 11
    s_add_u32 s32, s32, s33
    s_add_u32 s90, s32, 8388608
    s_add_u32 s91, s90, 65536
    s_lshl_b32 s32, s34, 11
    s_add_u32 s32, s32, s60
    s_add_u32 s32, s89, s32
    v_add_u32 v243, s32, v51
    s_lshl_b32 s32, s73, 7
    s_add_u32 s88, s32, 17301504
    s_lshl_b32 s32, s34, 6
    s_lshl_b32 s33, s26, 2
    s_add_u32 s32, s32, s33
    s_add_u32 s32, s32, s88
    v_writelane_b32 v243, s32, 32
    s_lshl_b32 s32, s27, 11
    s_add_u32 s85, s32, 17825792
    s_lshl_b32 s32, s26, 3
    s_add_u32 s84, s85, s32
    s_lshl_b32 s32, s28, 7
    s_add_u32 s66, s85, s32
    s_add_u32 s67, s84, s32
    s_and_b32 s64, s66, -256
    s_lshl_b32 s32, s26, 11
    s_lshl_b32 s33, s27, 3
    s_add_u32 s32, s32, s33
    s_add_u32 s92, s32, 17891328
    s_lshl_b32 s32, s70, 11
    s_add_u32 s93, s32, 17891328
    s_lshl_b32 s32, s70, 2
    s_add_u32 s32, s32, s28
    s_lshl_b32 s33, s32, 16
    s_add_u32 s94, s33, 8388608
    s_lshl_b32 s32, s32, 17
    s_lshl_b32 s33, s71, 7
    s_add_u32 s95, s32, s33
    s_and_b32 s16, s23, 3
    s_xor_b32 s17, s22, s16
    s_xor_b32 s17, s17, s100
    s_lshl_b32 s16, s17, 7
    s_mul_i32 s17, s17, 393216
    s_add_u32 m0, s19, s21
    s_add_u32 s18, s17, s39
    s_add_u32 s17, s17, s48
    buffer_load_dwordx4 v6, s[12:15], s17 offen offset:0 lds
    buffer_load_dwordx4 v7, s[12:15], s17 offen offset:1024 lds
    buffer_load_dwordx4 v8, s[12:15], s17 offen offset:2048 lds
    s_add_u32 m0, s19, s20
    s_add_u32 s22, s22, 1
    buffer_load_dwordx4 v2, s[8:11], s16 offen offset:0 lds
    buffer_load_dwordx4 v3, s[8:11], s16 offen offset:1024 lds
    buffer_load_dwordx4 v4, s[8:11], s16 offen offset:2048 lds
    buffer_load_dwordx4 v5, s[8:11], s16 offen offset:3072 lds
    s_lshl_b32 s33, s28, 10
    s_add_u32 m0, s33, 34816
    s_lshl_b32 s32, s27, 12
    s_add_u32 s32, s32, s33
    s_mov_b32 s76, s36
    s_mov_b32 s77, s37
    s_mov_b32 s78, 65536
    s_mov_b32 s79, 0x20000
    buffer_load_dwordx4 v30, s[76:79], s32 offen lds
    s_mov_b32 s40, s54
    s_mov_b32 s41, s55
    s_mov_b32 s42, 268435456
    s_mov_b32 s43, 0x20000
    s_mov_b32 s76, s50
    s_mov_b32 s77, s51
    s_mov_b32 s78, 8388608
    s_mov_b32 s79, 0x20000
    s_mov_b32 s44, s80
    s_mov_b32 s45, s81
    s_mov_b32 s46, 2097152
    s_mov_b32 s47, 0x20000
    v_lshrrev_b32 v14, 3, v1
    v_and_b32 v15, 7, v1
    v_and_b32 v16, 6, v14
    v_xor_b32 v15, v15, v16
    v_lshlrev_b32 v15, 4, v15
    v_lshl_add_u32 v15, v14, 11, v15
    s_lshl_b32 s32, s71, 7
    v_add_u32 v32, s32, v15
    s_and_b32 s65, s28, 2
    s_mul_i32 s65, s65, 6
    s_add_u32 s65, s65, s28
    v_mov_b32 v2, v242
    v_mov_b32 v3, v243
    v_mov_b32 v4, v244
    v_mov_b32 v5, v245
    v_mov_b32 v6, v246
    v_mov_b32 v7, v247
    v_mov_b32 v8, v248
    s_waitcnt vmcnt(8) lgkmcnt(0)
    s_mov_b32 s17, 0
    s_mov_b32 s18, 1
    s_mov_b32 s19, 40960
    s_barrier
    ds_read_b64_tr_b16 v[176:177], v12 offset:16384
    ds_read_b64_tr_b16 v[178:179], v12 offset:16896
    ds_read_b128 v[160:163], v9 offset:0
    ds_read_b128 v[164:167], v9 offset:2048
    ds_read_b128 v[168:171], v9 offset:4096
    ds_read_b128 v[172:175], v9 offset:6144
    ds_read_b64_tr_b16 v[180:181], v13 offset:16384
    ds_read_b64_tr_b16 v[182:183], v13 offset:16896
    ds_read_b64_tr_b16 v[184:185], v12 offset:17408
    ds_read_b64_tr_b16 v[186:187], v12 offset:17920
    ds_read_b64_tr_b16 v[188:189], v13 offset:17408
    ds_read_b64_tr_b16 v[190:191], v13 offset:17920
    ds_read_b64_tr_b16 v[192:193], v12 offset:18432
    s_waitcnt lgkmcnt(8)
    ds_read_b64_tr_b16 v[194:195], v12 offset:18944
    ds_read_b64_tr_b16 v[196:197], v13 offset:18432
    ds_read_b64_tr_b16 v[198:199], v13 offset:18944
G_loop:
    s_waitcnt lgkmcnt(0)
    v_mfma_f32_16x16x32_bf16 v[64:67], v[176:179], v[160:163], v[64:67]
    ds_read_b64_tr_b16 v[216:217], v12 offset:28672
    v_mfma_f32_16x16x32_bf16 v[68:71], v[176:179], v[164:167], v[68:71]
    ds_read_b64_tr_b16 v[218:219], v12 offset:29184
    v_mfma_f32_16x16x32_bf16 v[72:75], v[176:179], v[168:171], v[72:75]
    ds_read_b128 v[200:203], v10 offset:0
    v_mfma_f32_16x16x32_bf16 v[76:79], v[176:179], v[172:175], v[76:79]
    ds_read_b128 v[204:207], v10 offset:2048
    v_mfma_f32_16x16x32_bf16 v[92:95], v[180:183], v[172:175], v[92:95]
    ds_read_b128 v[208:211], v10 offset:4096
    v_mfma_f32_16x16x32_bf16 v[88:91], v[180:183], v[168:171], v[88:91]
    ds_read_b128 v[212:215], v10 offset:6144
    v_mfma_f32_16x16x32_bf16 v[84:87], v[180:183], v[164:167], v[84:87]
    ds_read_b64_tr_b16 v[220:221], v13 offset:28672
    v_mfma_f32_16x16x32_bf16 v[80:83], v[180:183], v[160:163], v[80:83]
    ds_read_b64_tr_b16 v[222:223], v13 offset:29184
    v_mfma_f32_16x16x32_bf16 v[96:99], v[184:187], v[160:163], v[96:99]
    ds_read_b64_tr_b16 v[224:225], v12 offset:29696
    v_mfma_f32_16x16x32_bf16 v[100:103], v[184:187], v[164:167], v[100:103]
    ds_read_b64_tr_b16 v[226:227], v12 offset:30208
    v_mfma_f32_16x16x32_bf16 v[104:107], v[184:187], v[168:171], v[104:107]
    ds_read_b64_tr_b16 v[228:229], v13 offset:29696
    v_mfma_f32_16x16x32_bf16 v[108:111], v[184:187], v[172:175], v[108:111]
    ds_read_b64_tr_b16 v[230:231], v13 offset:30208
    v_mfma_f32_16x16x32_bf16 v[124:127], v[188:191], v[172:175], v[124:127]
    ds_read_b64_tr_b16 v[232:233], v12 offset:30720
    v_mfma_f32_16x16x32_bf16 v[120:123], v[188:191], v[168:171], v[120:123]
    ds_read_b64_tr_b16 v[234:235], v12 offset:31232
    s_waitcnt lgkmcnt(10)
    v_mfma_f32_16x16x32_bf16 v[116:119], v[188:191], v[164:167], v[116:119]
    ds_read_b64_tr_b16 v[236:237], v13 offset:30720
    v_mfma_f32_16x16x32_bf16 v[112:115], v[188:191], v[160:163], v[112:115]
    ds_read_b64_tr_b16 v[238:239], v13 offset:31232
    v_mfma_f32_16x16x32_bf16 v[128:131], v[160:163], v[192:195], v[128:131]
    s_add_u32 s18, s18, 1
    s_cmp_eq_u32 s18, 3
    v_mfma_f32_16x16x32_bf16 v[144:147], v[160:163], v[196:199], v[144:147]
    s_cselect_b32 s16, 4294885376, s19
    s_cselect_b32 s18, 0, s18
    v_mfma_f32_16x16x32_bf16 v[148:151], v[164:167], v[196:199], v[148:151]
    v_add_u32 v9, s16, v9
    v_mfma_f32_16x16x32_bf16 v[132:135], v[164:167], v[192:195], v[132:135]
    v_add_u32 v10, s16, v10
    v_mfma_f32_16x16x32_bf16 v[136:139], v[168:171], v[192:195], v[136:139]
    v_add_u32 v12, s16, v12
    v_mfma_f32_16x16x32_bf16 v[152:155], v[168:171], v[196:199], v[152:155]
    v_add_u32 v13, s16, v13
    v_mfma_f32_16x16x32_bf16 v[156:159], v[172:175], v[196:199], v[156:159]
    s_cmp_eq_u32 s17, 15
    v_mfma_f32_16x16x32_bf16 v[140:143], v[172:175], v[192:195], v[140:143]
    s_waitcnt vmcnt(0) lgkmcnt(0)
    s_cbranch_scc1 G_last
    s_barrier
    v_mfma_f32_16x16x32_bf16 v[64:67], v[216:219], v[200:203], v[64:67]
    ds_read_b64_tr_b16 v[176:177], v12 offset:16384
    v_mfma_f32_16x16x32_bf16 v[68:71], v[216:219], v[204:207], v[68:71]
    ds_read_b64_tr_b16 v[178:179], v12 offset:16896
    v_mfma_f32_16x16x32_bf16 v[72:75], v[216:219], v[208:211], v[72:75]
    ds_read_b128 v[160:163], v9 offset:0
    v_mfma_f32_16x16x32_bf16 v[76:79], v[216:219], v[212:215], v[76:79]
    ds_read_b128 v[164:167], v9 offset:2048
    v_mfma_f32_16x16x32_bf16 v[92:95], v[220:223], v[212:215], v[92:95]
    ds_read_b128 v[168:171], v9 offset:4096
    v_mfma_f32_16x16x32_bf16 v[88:91], v[220:223], v[208:211], v[88:91]
    ds_read_b128 v[172:175], v9 offset:6144
    v_mfma_f32_16x16x32_bf16 v[84:87], v[220:223], v[204:207], v[84:87]
    ds_read_b64_tr_b16 v[180:181], v13 offset:16384
    v_mfma_f32_16x16x32_bf16 v[80:83], v[220:223], v[200:203], v[80:83]
    ds_read_b64_tr_b16 v[182:183], v13 offset:16896
    v_mfma_f32_16x16x32_bf16 v[96:99], v[224:227], v[200:203], v[96:99]
    ds_read_b64_tr_b16 v[184:185], v12 offset:17408
    v_mfma_f32_16x16x32_bf16 v[100:103], v[224:227], v[204:207], v[100:103]
    ds_read_b64_tr_b16 v[186:187], v12 offset:17920
    v_mfma_f32_16x16x32_bf16 v[104:107], v[224:227], v[208:211], v[104:107]
    ds_read_b64_tr_b16 v[188:189], v13 offset:17408
    v_mfma_f32_16x16x32_bf16 v[108:111], v[224:227], v[212:215], v[108:111]
    ds_read_b64_tr_b16 v[190:191], v13 offset:17920
    v_mfma_f32_16x16x32_bf16 v[124:127], v[228:231], v[212:215], v[124:127]
    ds_read_b64_tr_b16 v[192:193], v12 offset:18432
    v_mfma_f32_16x16x32_bf16 v[120:123], v[228:231], v[208:211], v[120:123]
    ds_read_b64_tr_b16 v[194:195], v12 offset:18944
    s_waitcnt lgkmcnt(10)
    v_mfma_f32_16x16x32_bf16 v[116:119], v[228:231], v[204:207], v[116:119]
    ds_read_b64_tr_b16 v[196:197], v13 offset:18432
    v_mfma_f32_16x16x32_bf16 v[112:115], v[228:231], v[200:203], v[112:115]
    ds_read_b64_tr_b16 v[198:199], v13 offset:18944
    v_mfma_f32_16x16x32_bf16 v[128:131], v[200:203], v[232:235], v[128:131]
    v_mfma_f32_16x16x32_bf16 v[144:147], v[200:203], v[236:239], v[144:147]
    v_mfma_f32_16x16x32_bf16 v[148:151], v[204:207], v[236:239], v[148:151]
    v_mfma_f32_16x16x32_bf16 v[132:135], v[204:207], v[232:235], v[132:135]
    v_mfma_f32_16x16x32_bf16 v[136:139], v[208:211], v[232:235], v[136:139]
    s_add_u32 s17, s17, 1
    s_cmp_lt_u32 s17, 16
    v_mfma_f32_16x16x32_bf16 v[152:155], v[208:211], v[236:239], v[152:155]
    v_mfma_f32_16x16x32_bf16 v[156:159], v[212:215], v[236:239], v[156:159]
    v_mfma_f32_16x16x32_bf16 v[140:143], v[212:215], v[232:235], v[140:143]
    s_branch G_loop
G_last:
    v_mfma_f32_16x16x32_bf16 v[96:99], v[224:227], v[200:203], v[96:99]
    ds_read_b64_tr_b16 v[18:19], v17 offset:0
    v_mfma_f32_16x16x32_bf16 v[100:103], v[224:227], v[204:207], v[100:103]
    ds_read_b64_tr_b16 v[20:21], v17 offset:256
    v_mfma_f32_16x16x32_bf16 v[116:119], v[228:231], v[204:207], v[116:119]
    ds_read_b64_tr_b16 v[22:23], v17 offset:1024
    v_mfma_f32_16x16x32_bf16 v[112:115], v[228:231], v[200:203], v[112:115]
    ds_read_b64_tr_b16 v[24:25], v17 offset:1280
    v_mfma_f32_16x16x32_bf16 v[120:123], v[228:231], v[208:211], v[120:123]
    s_mov_b64 exec, 1
    ds_add_u32 v26, v5 offset:40268
    s_mov_b64 exec, -1
    v_mfma_f32_16x16x32_bf16 v[124:127], v[228:231], v[212:215], v[124:127]
    ds_read_b64 v[28:29], v26 offset:40288
    v_mfma_f32_16x16x32_bf16 v[108:111], v[224:227], v[212:215], v[108:111]
    ds_read_b32 v14, v26 offset:40296
    v_mfma_f32_16x16x32_bf16 v[104:107], v[224:227], v[208:211], v[104:107]
    v_mfma_f32_16x16x32_bf16 v[128:131], v[200:203], v[232:235], v[128:131]
    v_cvt_pk_bf16_f32 v224, v96, v97
    v_cvt_pk_bf16_f32 v226, v100, v101
    v_mfma_f32_16x16x32_bf16 v[144:147], v[200:203], v[236:239], v[144:147]
    v_cvt_pk_bf16_f32 v225, v98, v99
    v_cvt_pk_bf16_f32 v227, v102, v103
    v_mfma_f32_16x16x32_bf16 v[148:151], v[204:207], v[236:239], v[148:151]
    v_cvt_pk_bf16_f32 v228, v112, v113
    v_cvt_pk_bf16_f32 v230, v116, v117
    v_mfma_f32_16x16x32_bf16 v[132:135], v[204:207], v[232:235], v[132:135]
    v_cvt_pk_bf16_f32 v229, v114, v115
    v_cvt_pk_bf16_f32 v231, v118, v119
    v_mfma_f32_16x16x32_bf16 v[136:139], v[208:211], v[232:235], v[136:139]
    v_permlane16_swap_b32 v224, v226
    v_mfma_f32_16x16x32_bf16 v[152:155], v[208:211], v[236:239], v[152:155]
    v_permlane16_swap_b32 v225, v227
    v_mfma_f32_16x16x32_bf16 v[156:159], v[212:215], v[236:239], v[156:159]
    v_permlane16_swap_b32 v228, v230
    v_mfma_f32_16x16x32_bf16 v[140:143], v[212:215], v[232:235], v[140:143]
    v_permlane16_swap_b32 v229, v231
    v_mfma_f32_16x16x32_bf16 v[64:67], v[216:219], v[200:203], v[64:67]
    v_cvt_pk_bf16_f32 v244, v120, v121
    v_cvt_pk_bf16_f32 v246, v124, v125
    s_waitcnt lgkmcnt(0)
    v_readfirstlane_b32 s49, v14
    v_mfma_f32_32x32x16_bf16 v[160:175], v[18:21], v[224:227], 0
    v_mfma_f32_32x32x16_bf16 v[160:175], v[22:25], v[228:231], v[160:175]
    v_mfma_f32_16x16x32_bf16 v[68:71], v[216:219], v[204:207], v[68:71]
    v_cvt_pk_bf16_f32 v245, v122, v123
    v_cvt_pk_bf16_f32 v247, v126, v127
    v_mfma_f32_16x16x32_bf16 v[72:75], v[216:219], v[208:211], v[72:75]
    v_cvt_pk_bf16_f32 v240, v104, v105
    v_cvt_pk_bf16_f32 v242, v108, v109
    v_mfma_f32_16x16x32_bf16 v[76:79], v[216:219], v[212:215], v[76:79]
    v_cvt_pk_bf16_f32 v241, v106, v107
    v_cvt_pk_bf16_f32 v243, v110, v111
    v_mfma_f32_16x16x32_bf16 v[92:95], v[220:223], v[212:215], v[92:95]
    v_permlane16_swap_b32 v244, v246
    v_mfma_f32_16x16x32_bf16 v[88:91], v[220:223], v[208:211], v[88:91]
    v_permlane16_swap_b32 v245, v247
    v_mfma_f32_16x16x32_bf16 v[84:87], v[220:223], v[204:207], v[84:87]
    v_permlane16_swap_b32 v240, v242
    v_mfma_f32_16x16x32_bf16 v[80:83], v[220:223], v[200:203], v[80:83]
    v_permlane16_swap_b32 v241, v243
    ds_read_b32 v16, v26 offset:40268
    v_max3_f32 v34, v160, v161, v162
    v_min3_f32 v36, v160, v161, v162
    v_mfma_f32_32x32x16_bf16 v[192:207], v[18:21], v[240:243], 0
    v_max3_f32 v34, v34, v163, v164
    v_min3_f32 v36, v36, v163, v164
    v_max3_f32 v34, v34, v165, v166
    v_min3_f32 v36, v36, v165, v166
    v_max3_f32 v34, v34, v167, v168
    v_min3_f32 v36, v36, v167, v168
    v_mfma_f32_32x32x16_bf16 v[192:207], v[22:25], v[244:247], v[192:207]
    v_max3_f32 v34, v34, v169, v170
    v_min3_f32 v36, v36, v169, v170
    v_max3_f32 v34, v34, v171, v172
    v_min3_f32 v36, v36, v171, v172
    v_max3_f32 v34, v34, v173, v174
    v_min3_f32 v36, v36, v173, v174
    v_max_f32 v34, v34, v175
    v_min_f32 v36, v36, v175
    v_mul_f32 v34, 0xbfb8aa3b, v34
    v_mul_f32 v36, 1069066811, v36
    s_waitcnt lgkmcnt(0)
    v_cmp_gt_u32 vcc, 4, v16
    v_cvt_pk_bf16_f32 v96, v128, v129
    v_cvt_pk_bf16_f32 v98, v144, v145
    v_permlane32_swap_b32 v34, v36
    v_min_f32 v34, v34, v36
    v_mov_b32 v36, v34
    v_cvt_pk_bf16_f32 v97, v130, v131
    v_cvt_pk_bf16_f32 v99, v146, v147
    v_permlane32_swap_b32 v34, v36
    s_cbranch_vccnz GE_slow
GE_back:
    v_pk_fma_f32 v[176:177], v[160:161], s[56:57], v[36:37] op_sel_hi:[1,1,0] neg_lo:[1,0,0] neg_hi:[1,0,0]
    v_pk_fma_f32 v[160:161], v[160:161], s[56:57], v[34:35] op_sel_hi:[1,1,0]
    v_pk_fma_f32 v[178:179], v[162:163], s[56:57], v[36:37] op_sel_hi:[1,1,0] neg_lo:[1,0,0] neg_hi:[1,0,0]
    v_pk_fma_f32 v[162:163], v[162:163], s[56:57], v[34:35] op_sel_hi:[1,1,0]
    v_pk_fma_f32 v[180:181], v[164:165], s[56:57], v[36:37] op_sel_hi:[1,1,0] neg_lo:[1,0,0] neg_hi:[1,0,0]
    v_pk_fma_f32 v[164:165], v[164:165], s[56:57], v[34:35] op_sel_hi:[1,1,0]
    v_pk_fma_f32 v[182:183], v[166:167], s[56:57], v[36:37] op_sel_hi:[1,1,0] neg_lo:[1,0,0] neg_hi:[1,0,0]
    v_pk_fma_f32 v[166:167], v[166:167], s[56:57], v[34:35] op_sel_hi:[1,1,0]
    v_pk_fma_f32 v[184:185], v[168:169], s[56:57], v[36:37] op_sel_hi:[1,1,0] neg_lo:[1,0,0] neg_hi:[1,0,0]
    v_pk_fma_f32 v[168:169], v[168:169], s[56:57], v[34:35] op_sel_hi:[1,1,0]
    v_pk_fma_f32 v[186:187], v[170:171], s[56:57], v[36:37] op_sel_hi:[1,1,0] neg_lo:[1,0,0] neg_hi:[1,0,0]
    v_pk_fma_f32 v[170:171], v[170:171], s[56:57], v[34:35] op_sel_hi:[1,1,0]
    v_pk_fma_f32 v[188:189], v[172:173], s[56:57], v[36:37] op_sel_hi:[1,1,0] neg_lo:[1,0,0] neg_hi:[1,0,0]
    v_pk_fma_f32 v[172:173], v[172:173], s[56:57], v[34:35] op_sel_hi:[1,1,0]
    v_pk_fma_f32 v[190:191], v[174:175], s[56:57], v[36:37] op_sel_hi:[1,1,0] neg_lo:[1,0,0] neg_hi:[1,0,0]
    v_pk_fma_f32 v[174:175], v[174:175], s[56:57], v[34:35] op_sel_hi:[1,1,0]
    v_exp_f32 v160, v160
    v_max3_f32 v42, v192, v193, v194
    v_cvt_pk_bf16_f32 v100, v132, v133
    v_exp_f32 v161, v161
    v_min3_f32 v44, v192, v193, v194
    v_exp_f32 v176, v176
    v_cvt_pk_bf16_f32 v102, v148, v149
    v_max3_f32 v42, v42, v195, v196
    v_exp_f32 v177, v177
    v_min3_f32 v44, v44, v195, v196
    v_exp_f32 v162, v162
    v_cvt_pk_bf16_f32 v101, v134, v135
    v_max3_f32 v42, v42, v197, v198
    v_exp_f32 v163, v163
    v_cvt_pk_bf16_f32 v103, v150, v151
    v_exp_f32 v178, v178
    v_min3_f32 v44, v44, v197, v198
    v_exp_f32 v179, v179
    v_max3_f32 v42, v42, v199, v200
    v_permlane16_swap_b32 v96, v98
    v_exp_f32 v164, v164
    v_min3_f32 v44, v44, v199, v200
    v_exp_f32 v165, v165
    v_permlane16_swap_b32 v97, v99
    v_max3_f32 v42, v42, v201, v202
    v_exp_f32 v180, v180
    v_min3_f32 v44, v44, v201, v202
    v_exp_f32 v181, v181
    ds_write_b128 v50, v[96:99] offset:0
    v_pk_add_f32 v[38:39], v[160:161], v[162:163]
    v_max3_f32 v42, v42, v203, v204
    v_min3_f32 v44, v44, v203, v204
    v_pk_add_f32 v[40:41], v[176:177], v[178:179]
    v_cvt_pk_bf16_f32 v104, v136, v137
    v_exp_f32 v166, v166
    v_max3_f32 v42, v42, v205, v206
    v_cvt_pk_bf16_f32 v106, v152, v153
    v_exp_f32 v167, v167
    v_min3_f32 v44, v44, v205, v206
    v_exp_f32 v182, v182
    v_max_f32 v42, v42, v207
    v_exp_f32 v183, v183
    v_cvt_pk_bf16_f32 v105, v138, v139
    v_min_f32 v44, v44, v207
    v_pk_add_f32 v[38:39], v[38:39], v[164:165]
    v_cvt_pk_bf16_f32 v107, v154, v155
    v_pk_add_f32 v[40:41], v[40:41], v[180:181]
    v_mul_f32 v42, 0xbfb8aa3b, v42
    v_mul_f32 v44, 1069066811, v44
    v_exp_f32 v168, v168
    v_permlane16_swap_b32 v100, v102
    v_exp_f32 v169, v169
    v_permlane32_swap_b32 v42, v44
    v_exp_f32 v184, v184
    v_min_f32 v42, v42, v44
    v_permlane16_swap_b32 v101, v103
    v_exp_f32 v185, v185
    v_mov_b32 v44, v42
    v_pk_add_f32 v[38:39], v[38:39], v[166:167]
    ds_write_b128 v50, v[100:103] offset:1024
    v_permlane32_swap_b32 v42, v44
    v_pk_add_f32 v[40:41], v[40:41], v[182:183]
    v_pk_fma_f32 v[208:209], v[192:193], s[56:57], v[44:45] op_sel_hi:[1,1,0] neg_lo:[1,0,0] neg_hi:[1,0,0]
    v_exp_f32 v170, v170
    v_cvt_pk_bf16_f32 v108, v140, v141
    v_pk_fma_f32 v[192:193], v[192:193], s[56:57], v[42:43] op_sel_hi:[1,1,0]
    v_exp_f32 v171, v171
    v_cvt_pk_bf16_f32 v110, v156, v157
    v_exp_f32 v186, v186
    v_pk_fma_f32 v[210:211], v[194:195], s[56:57], v[44:45] op_sel_hi:[1,1,0] neg_lo:[1,0,0] neg_hi:[1,0,0]
    v_exp_f32 v187, v187
    v_pk_fma_f32 v[194:195], v[194:195], s[56:57], v[42:43] op_sel_hi:[1,1,0]
    v_cvt_pk_bf16_f32 v109, v142, v143
    v_pk_add_f32 v[38:39], v[38:39], v[168:169]
    v_pk_fma_f32 v[212:213], v[196:197], s[56:57], v[44:45] op_sel_hi:[1,1,0] neg_lo:[1,0,0] neg_hi:[1,0,0]
    v_pk_add_f32 v[40:41], v[40:41], v[184:185]
    v_cvt_pk_bf16_f32 v111, v158, v159
    v_pk_fma_f32 v[196:197], v[196:197], s[56:57], v[42:43] op_sel_hi:[1,1,0]
    v_exp_f32 v172, v172
    v_pk_fma_f32 v[214:215], v[198:199], s[56:57], v[44:45] op_sel_hi:[1,1,0] neg_lo:[1,0,0] neg_hi:[1,0,0]
    v_exp_f32 v173, v173
    v_permlane16_swap_b32 v104, v106
    v_exp_f32 v188, v188
    v_pk_fma_f32 v[198:199], v[198:199], s[56:57], v[42:43] op_sel_hi:[1,1,0]
    v_pk_fma_f32 v[216:217], v[200:201], s[56:57], v[44:45] op_sel_hi:[1,1,0] neg_lo:[1,0,0] neg_hi:[1,0,0]
    v_exp_f32 v189, v189
    v_permlane16_swap_b32 v105, v107
    v_pk_add_f32 v[38:39], v[38:39], v[170:171]
    v_pk_fma_f32 v[200:201], v[200:201], s[56:57], v[42:43] op_sel_hi:[1,1,0]
    ds_write_b128 v50, v[104:107] offset:2048
    v_pk_add_f32 v[40:41], v[40:41], v[186:187]
    v_pk_fma_f32 v[218:219], v[202:203], s[56:57], v[44:45] op_sel_hi:[1,1,0] neg_lo:[1,0,0] neg_hi:[1,0,0]
    v_exp_f32 v174, v174
    v_pk_fma_f32 v[202:203], v[202:203], s[56:57], v[42:43] op_sel_hi:[1,1,0]
    v_exp_f32 v175, v175
    v_permlane16_swap_b32 v108, v110
    v_pk_fma_f32 v[220:221], v[204:205], s[56:57], v[44:45] op_sel_hi:[1,1,0] neg_lo:[1,0,0] neg_hi:[1,0,0]
    v_exp_f32 v190, v190
    v_permlane16_swap_b32 v109, v111
    v_exp_f32 v191, v191
    v_pk_fma_f32 v[204:205], v[204:205], s[56:57], v[42:43] op_sel_hi:[1,1,0]
    v_pk_fma_f32 v[222:223], v[206:207], s[56:57], v[44:45] op_sel_hi:[1,1,0] neg_lo:[1,0,0] neg_hi:[1,0,0]
    v_pk_add_f32 v[38:39], v[38:39], v[172:173]
    ds_write_b128 v50, v[108:111] offset:3072
    v_pk_add_f32 v[40:41], v[40:41], v[188:189]
    v_pk_fma_f32 v[206:207], v[206:207], s[56:57], v[42:43] op_sel_hi:[1,1,0]
    v_exp_f32 v192, v192
    v_pk_add_f32 v[38:39], v[38:39], v[174:175]
    v_pk_add_f32 v[40:41], v[40:41], v[190:191]
    v_exp_f32 v193, v193
    v_add_f32 v38, v38, v39
    v_exp_f32 v208, v208
    v_add_f32 v40, v40, v41
    v_exp_f32 v209, v209
    s_nop 0
    v_permlane32_swap_b32 v38, v40
    v_exp_f32 v194, v194
    v_add_f32 v38, v38, v40
    v_exp_f32 v195, v195
    v_rcp_f32 v38, v38
    v_exp_f32 v210, v210
    v_mov_b32 v40, v38
    v_exp_f32 v211, v211
    s_nop 0
    v_permlane32_swap_b32 v38, v40
    v_exp_f32 v196, v196
    v_pk_mul_f32 v[160:161], v[160:161], v[38:39] op_sel_hi:[1,0]
    v_pk_mul_f32 v[162:163], v[162:163], v[38:39] op_sel_hi:[1,0]
    v_exp_f32 v197, v197
    v_pk_mul_f32 v[176:177], v[176:177], v[40:41] op_sel_hi:[1,0]
    v_exp_f32 v212, v212
    v_pk_mul_f32 v[178:179], v[178:179], v[40:41] op_sel_hi:[1,0]
    v_exp_f32 v213, v213
    v_cvt_pk_bf16_f32 v224, v160, v161
    v_pk_add_f32 v[46:47], v[192:193], v[194:195]
    v_cvt_pk_bf16_f32 v225, v162, v163
    v_pk_add_f32 v[48:49], v[208:209], v[210:211]
    ds_write_b64 v52, v[224:225] offset:0
    v_exp_f32 v198, v198
    v_cvt_pk_bf16_f32 v232, v176, v177
    v_exp_f32 v199, v199
    v_cvt_pk_bf16_f32 v233, v178, v179
    v_exp_f32 v214, v214
    ds_write_b64 v52, v[232:233] offset:8192
    v_exp_f32 v215, v215
    v_pk_mul_f32 v[164:165], v[164:165], v[38:39] op_sel_hi:[1,0]
    v_pk_mul_f32 v[166:167], v[166:167], v[38:39] op_sel_hi:[1,0]
    v_pk_add_f32 v[46:47], v[46:47], v[196:197]
    v_pk_mul_f32 v[180:181], v[180:181], v[40:41] op_sel_hi:[1,0]
    v_pk_add_f32 v[48:49], v[48:49], v[212:213]
    v_pk_mul_f32 v[182:183], v[182:183], v[40:41] op_sel_hi:[1,0]
    v_exp_f32 v200, v200
    v_cvt_pk_bf16_f32 v226, v164, v165
    v_exp_f32 v201, v201
    v_cvt_pk_bf16_f32 v227, v166, v167
    v_exp_f32 v216, v216
    ds_write_b64 v53, v[226:227] offset:0
    v_exp_f32 v217, v217
    v_cvt_pk_bf16_f32 v234, v180, v181
    v_pk_add_f32 v[46:47], v[46:47], v[198:199]
    v_cvt_pk_bf16_f32 v235, v182, v183
    v_pk_add_f32 v[48:49], v[48:49], v[214:215]
    ds_write_b64 v53, v[234:235] offset:8192
    v_exp_f32 v202, v202
    v_pk_mul_f32 v[168:169], v[168:169], v[38:39] op_sel_hi:[1,0]
    v_pk_mul_f32 v[170:171], v[170:171], v[38:39] op_sel_hi:[1,0]
    v_exp_f32 v203, v203
    v_pk_mul_f32 v[184:185], v[184:185], v[40:41] op_sel_hi:[1,0]
    v_exp_f32 v218, v218
    v_pk_mul_f32 v[186:187], v[186:187], v[40:41] op_sel_hi:[1,0]
    v_exp_f32 v219, v219
    v_cvt_pk_bf16_f32 v228, v168, v169
    v_pk_add_f32 v[46:47], v[46:47], v[200:201]
    v_cvt_pk_bf16_f32 v229, v170, v171
    v_pk_add_f32 v[48:49], v[48:49], v[216:217]
    ds_write_b64 v54, v[228:229] offset:0
    v_exp_f32 v204, v204
    v_cvt_pk_bf16_f32 v236, v184, v185
    v_exp_f32 v205, v205
    v_cvt_pk_bf16_f32 v237, v186, v187
    v_exp_f32 v220, v220
    ds_write_b64 v54, v[236:237] offset:8192
    v_exp_f32 v221, v221
    v_pk_mul_f32 v[172:173], v[172:173], v[38:39] op_sel_hi:[1,0]
    v_pk_mul_f32 v[174:175], v[174:175], v[38:39] op_sel_hi:[1,0]
    v_pk_add_f32 v[46:47], v[46:47], v[202:203]
    v_pk_mul_f32 v[188:189], v[188:189], v[40:41] op_sel_hi:[1,0]
    v_pk_add_f32 v[48:49], v[48:49], v[218:219]
    v_pk_mul_f32 v[190:191], v[190:191], v[40:41] op_sel_hi:[1,0]
    v_exp_f32 v206, v206
    v_cvt_pk_bf16_f32 v230, v172, v173
    v_exp_f32 v207, v207
    v_cvt_pk_bf16_f32 v231, v174, v175
    v_exp_f32 v222, v222
    ds_write_b64 v55, v[230:231] offset:0
    v_exp_f32 v223, v223
    v_cvt_pk_bf16_f32 v238, v188, v189
    v_pk_add_f32 v[46:47], v[46:47], v[204:205]
    v_cvt_pk_bf16_f32 v239, v190, v191
    v_pk_add_f32 v[48:49], v[48:49], v[220:221]
    ds_write_b64 v55, v[238:239] offset:8192
    ds_read_b64_tr_b16 v[160:161], v56 offset:0
    v_pk_add_f32 v[46:47], v[46:47], v[206:207]
    v_pk_add_f32 v[48:49], v[48:49], v[222:223]
    v_add_f32 v46, v46, v47
    v_add_f32 v48, v48, v49
    ds_read_b64_tr_b16 v[162:163], v57 offset:256
    ds_read_b64_tr_b16 v[164:165], v56 offset:1024
    v_permlane32_swap_b32 v46, v48
    v_add_f32 v46, v46, v48
    v_rcp_f32 v46, v46
    ds_read_b64_tr_b16 v[166:167], v57 offset:1280
    v_mov_b32 v48, v46
    v_xor_b32 v9, 4096, v56
    v_xor_b32 v10, 4096, v57
    v_permlane32_swap_b32 v46, v48
    v_pk_mul_f32 v[192:193], v[192:193], v[46:47] op_sel_hi:[1,0]
    v_pk_mul_f32 v[194:195], v[194:195], v[46:47] op_sel_hi:[1,0]
    v_pk_mul_f32 v[208:209], v[208:209], v[48:49] op_sel_hi:[1,0]
    v_pk_mul_f32 v[210:211], v[210:211], v[48:49] op_sel_hi:[1,0]
    v_cvt_pk_bf16_f32 v240, v192, v193
    v_cvt_pk_bf16_f32 v241, v194, v195
    ds_write_b64 v52, v[240:241] offset:2048
    v_cvt_pk_bf16_f32 v248, v208, v209
    v_cvt_pk_bf16_f32 v249, v210, v211
    ds_write_b64 v52, v[248:249] offset:10240
    v_pk_mul_f32 v[196:197], v[196:197], v[46:47] op_sel_hi:[1,0]
    v_pk_mul_f32 v[198:199], v[198:199], v[46:47] op_sel_hi:[1,0]
    v_pk_mul_f32 v[212:213], v[212:213], v[48:49] op_sel_hi:[1,0]
    v_pk_mul_f32 v[214:215], v[214:215], v[48:49] op_sel_hi:[1,0]
    v_cvt_pk_bf16_f32 v242, v196, v197
    v_cvt_pk_bf16_f32 v243, v198, v199
    ds_write_b64 v53, v[242:243] offset:2048
    v_cvt_pk_bf16_f32 v250, v212, v213
    v_cvt_pk_bf16_f32 v251, v214, v215
    ds_write_b64 v53, v[250:251] offset:10240
    v_pk_mul_f32 v[200:201], v[200:201], v[46:47] op_sel_hi:[1,0]
    v_pk_mul_f32 v[202:203], v[202:203], v[46:47] op_sel_hi:[1,0]
    v_pk_mul_f32 v[216:217], v[216:217], v[48:49] op_sel_hi:[1,0]
    v_pk_mul_f32 v[218:219], v[218:219], v[48:49] op_sel_hi:[1,0]
    v_cvt_pk_bf16_f32 v244, v200, v201
    v_cvt_pk_bf16_f32 v245, v202, v203
    ds_write_b64 v54, v[244:245] offset:2048
    v_cvt_pk_bf16_f32 v252, v216, v217
    v_cvt_pk_bf16_f32 v253, v218, v219
    ds_write_b64 v54, v[252:253] offset:10240
    v_pk_mul_f32 v[204:205], v[204:205], v[46:47] op_sel_hi:[1,0]
    v_pk_mul_f32 v[206:207], v[206:207], v[46:47] op_sel_hi:[1,0]
    v_pk_mul_f32 v[220:221], v[220:221], v[48:49] op_sel_hi:[1,0]
    v_pk_mul_f32 v[222:223], v[222:223], v[48:49] op_sel_hi:[1,0]
    v_cvt_pk_bf16_f32 v246, v204, v205
    v_cvt_pk_bf16_f32 v247, v206, v207
    ds_write_b64 v55, v[246:247] offset:2048
    v_cvt_pk_bf16_f32 v254, v220, v221
    v_cvt_pk_bf16_f32 v255, v222, v223
    ds_write_b64 v55, v[254:255] offset:10240
    s_mov_b64 exec, 1
    ds_add_u32 v4, v5 offset:40192
    s_mov_b64 exec, -1
    ds_read_b64_tr_b16 v[168:169], v56 offset:2048
    ds_read_b64_tr_b16 v[170:171], v57 offset:2304
    ds_read_b64_tr_b16 v[172:173], v56 offset:3072
    ds_read_b64_tr_b16 v[174:175], v57 offset:3328
    ds_read_b32 v16, v4 offset:40192
    s_waitcnt lgkmcnt(14)
    v_mfma_f32_32x32x16_bf16 v[112:127], v[160:163], v[96:99], 0
    v_cvt_pk_bf16_f32 v128, v64, v65
    v_cvt_pk_bf16_f32 v130, v68, v69
    v_cvt_pk_bf16_f32 v129, v66, v67
    v_cvt_pk_bf16_f32 v131, v70, v71
    v_mfma_f32_32x32x16_bf16 v[112:127], v[164:167], v[100:103], v[112:127]
    v_cvt_pk_bf16_f32 v132, v80, v81
    v_cvt_pk_bf16_f32 v134, v84, v85
    v_cvt_pk_bf16_f32 v133, v82, v83
    v_cvt_pk_bf16_f32 v135, v86, v87
    v_mfma_f32_16x16x32_bf16 v[216:219], v[60:63], v[160:163], 0
    v_permlane16_swap_b32 v128, v130
    v_mfma_f32_16x16x32_bf16 v[216:219], v[60:63], v[164:167], v[216:219]
    s_waitcnt lgkmcnt(0)
    v_cmp_gt_u32 vcc, 2, v16
    v_mfma_f32_32x32x16_bf16 v[112:127], v[168:171], v[104:107], v[112:127]
    s_cbranch_vccnz GP_slow
GP_back:
    ds_read_b64_tr_b16 v[176:177], v9 offset:0
    ds_read_b64_tr_b16 v[178:179], v10 offset:256
    ds_read_b128 v[144:147], v7 offset:0
    ds_read_b64_tr_b16 v[180:181], v9 offset:1024
    ds_read_b64_tr_b16 v[182:183], v10 offset:1280
    ds_read_b128 v[148:151], v7 offset:1024
    v_mfma_f32_32x32x16_bf16 v[112:127], v[172:175], v[108:111], v[112:127]
    ds_read_b64_tr_b16 v[184:185], v9 offset:2048
    ds_read_b64_tr_b16 v[186:187], v10 offset:2304
    ds_read_b128 v[152:155], v7 offset:2048
    ds_read_b64_tr_b16 v[188:189], v9 offset:3072
    ds_read_b64_tr_b16 v[190:191], v10 offset:3328
    ds_read_b128 v[156:159], v7 offset:3072
    v_mfma_f32_16x16x32_bf16 v[216:219], v[60:63], v[168:171], v[216:219]
    ds_read_b32 v16, v26 offset:40200
    v_mfma_f32_16x16x32_bf16 v[216:219], v[60:63], v[172:175], v[216:219]
    s_waitcnt lgkmcnt(10)
    v_mfma_f32_32x32x16_bf16 v[112:127], v[176:179], v[144:147], v[112:127]
    v_permlane16_swap_b32 v129, v131
    v_cvt_pk_bf16_f32 v136, v72, v73
    v_cvt_pk_bf16_f32 v138, v76, v77
    v_cvt_pk_bf16_f32 v137, v74, v75
    s_waitcnt lgkmcnt(7)
    v_mfma_f32_32x32x16_bf16 v[112:127], v[180:183], v[148:151], v[112:127]
    v_cvt_pk_bf16_f32 v139, v78, v79
    v_permlane16_swap_b32 v132, v134
    v_permlane16_swap_b32 v133, v135
    v_cvt_pk_bf16_f32 v140, v88, v89
    s_waitcnt lgkmcnt(4)
    v_mfma_f32_32x32x16_bf16 v[112:127], v[184:187], v[152:155], v[112:127]
    v_cvt_pk_bf16_f32 v142, v92, v93
    v_cvt_pk_bf16_f32 v141, v90, v91
    v_cvt_pk_bf16_f32 v143, v94, v95
    v_permlane16_swap_b32 v136, v138
    s_waitcnt lgkmcnt(1)
    v_mfma_f32_32x32x16_bf16 v[112:127], v[188:191], v[156:159], v[112:127]
    v_permlane16_swap_b32 v137, v139
    v_permlane16_swap_b32 v140, v142
    v_permlane16_swap_b32 v141, v143
    s_waitcnt lgkmcnt(0)
    v_cmp_gt_u32 vcc, 4, v16
    v_mfma_f32_16x16x32_bf16 v[216:219], v[60:63], v[176:179], v[216:219]
    v_mfma_f32_16x16x32_bf16 v[216:219], v[60:63], v[180:183], v[216:219]
    v_mfma_f32_16x16x32_bf16 v[216:219], v[60:63], v[184:187], v[216:219]
    v_mfma_f32_16x16x32_bf16 v[216:219], v[60:63], v[188:191], v[216:219]
    s_cbranch_vccnz GU_slow
GU_back:
    v_mfma_f32_32x32x16_bf16 v[160:175], v[18:21], v[128:131], 0
    s_nop 0
    v_cvt_pk_bf16_f32 v208, v112, v113
    v_cvt_pk_bf16_f32 v209, v114, v115
    v_cvt_pk_bf16_f32 v210, v116, v117
    v_cvt_pk_bf16_f32 v211, v118, v119
    v_cvt_pk_bf16_f32 v212, v120, v121
    v_mfma_f32_32x32x16_bf16 v[160:175], v[22:25], v[132:135], v[160:175]
    v_cvt_pk_bf16_f32 v213, v122, v123
    v_cvt_pk_bf16_f32 v214, v124, v125
    v_cvt_pk_bf16_f32 v215, v126, v127
    s_cmp_eq_u32 s49, 0
    s_cbranch_scc1 X11_slow
    buffer_store_dwordx4 v[208:211], v30, s[40:43], s82 offen offset:0
    buffer_store_dwordx4 v[212:215], v30, s[40:43], s82 offen offset:1024
    s_mov_b64 exec, 0xffff
    buffer_store_dwordx2 v[216:217], v8, s[40:43], s83 offen
    s_mov_b64 exec, -1
X11_back:
    v_mfma_f32_32x32x16_bf16 v[192:207], v[18:21], v[136:139], 0
    v_mov_b32 v144, v60
    v_mov_b32 v145, v60
    v_mov_b32 v146, v60
    v_mov_b32 v147, v60
    v_mov_b32 v148, v60
    v_mfma_f32_32x32x16_bf16 v[192:207], v[22:25], v[140:143], v[192:207]
    v_max3_f32 v34, v160, v161, v162
    v_min3_f32 v36, v160, v161, v162
    v_max3_f32 v34, v34, v163, v164
    v_min3_f32 v36, v36, v163, v164
    v_max3_f32 v34, v34, v165, v166
    v_min3_f32 v36, v36, v165, v166
    v_max3_f32 v34, v34, v167, v168
    v_min3_f32 v36, v36, v167, v168
    v_max3_f32 v34, v34, v169, v170
    v_min3_f32 v36, v36, v169, v170
    v_max3_f32 v34, v34, v171, v172
    v_min3_f32 v36, v36, v171, v172
    v_max3_f32 v34, v34, v173, v174
    v_max3_f32 v42, v192, v193, v194
    v_min3_f32 v36, v36, v173, v174
    v_min3_f32 v44, v192, v193, v194
    v_max_f32 v34, v34, v175
    v_max3_f32 v42, v42, v195, v196
    v_min_f32 v36, v36, v175
    v_min3_f32 v44, v44, v195, v196
    v_mul_f32 v34, 0xbfb8aa3b, v34
    v_max3_f32 v42, v42, v197, v198
    v_mul_f32 v36, 1069066811, v36
    v_min3_f32 v44, v44, v197, v198
    s_nop 0
    v_permlane32_swap_b32 v34, v36
    v_max3_f32 v42, v42, v199, v200
    v_min_f32 v34, v34, v36
    v_min3_f32 v44, v44, v199, v200
    v_mov_b32 v36, v34
    v_max3_f32 v42, v42, v201, v202
    s_nop 0
    v_permlane32_swap_b32 v34, v36
    v_min3_f32 v44, v44, v201, v202
    v_pk_fma_f32 v[176:177], v[160:161], s[56:57], v[36:37] op_sel_hi:[1,1,0] neg_lo:[1,0,0] neg_hi:[1,0,0]
    v_max3_f32 v42, v42, v203, v204
    v_pk_fma_f32 v[160:161], v[160:161], s[56:57], v[34:35] op_sel_hi:[1,1,0]
    v_min3_f32 v44, v44, v203, v204
    v_pk_fma_f32 v[178:179], v[162:163], s[56:57], v[36:37] op_sel_hi:[1,1,0] neg_lo:[1,0,0] neg_hi:[1,0,0]
    v_max3_f32 v42, v42, v205, v206
    v_pk_fma_f32 v[162:163], v[162:163], s[56:57], v[34:35] op_sel_hi:[1,1,0]
    v_min3_f32 v44, v44, v205, v206
    v_pk_fma_f32 v[180:181], v[164:165], s[56:57], v[36:37] op_sel_hi:[1,1,0] neg_lo:[1,0,0] neg_hi:[1,0,0]
    v_max_f32 v42, v42, v207
    v_pk_fma_f32 v[164:165], v[164:165], s[56:57], v[34:35] op_sel_hi:[1,1,0]
    v_min_f32 v44, v44, v207
    s_waitcnt vmcnt(0)
    s_mov_b64 exec, 1
    s_cmp_eq_u32 s49, 0
    s_cbranch_scc1 X12_slow
    buffer_store_dwordx2 v[28:29], v26, s[40:43], s67 offen offset:512
X12_back:
    s_mov_b64 exec, -1
    v_pk_fma_f32 v[182:183], v[166:167], s[56:57], v[36:37] op_sel_hi:[1,1,0] neg_lo:[1,0,0] neg_hi:[1,0,0]
    v_mul_f32 v42, 0xbfb8aa3b, v42
    v_pk_fma_f32 v[166:167], v[166:167], s[56:57], v[34:35] op_sel_hi:[1,1,0]
    v_mul_f32 v44, 1069066811, v44
    v_pk_fma_f32 v[184:185], v[168:169], s[56:57], v[36:37] op_sel_hi:[1,1,0] neg_lo:[1,0,0] neg_hi:[1,0,0]
    s_nop 0
    v_permlane32_swap_b32 v42, v44
    v_pk_fma_f32 v[168:169], v[168:169], s[56:57], v[34:35] op_sel_hi:[1,1,0]
    v_min_f32 v42, v42, v44
    v_pk_fma_f32 v[186:187], v[170:171], s[56:57], v[36:37] op_sel_hi:[1,1,0] neg_lo:[1,0,0] neg_hi:[1,0,0]
    v_mov_b32 v44, v42
    v_pk_fma_f32 v[170:171], v[170:171], s[56:57], v[34:35] op_sel_hi:[1,1,0]
    s_nop 0
    v_permlane32_swap_b32 v42, v44
    v_pk_fma_f32 v[188:189], v[172:173], s[56:57], v[36:37] op_sel_hi:[1,1,0] neg_lo:[1,0,0] neg_hi:[1,0,0]
    v_pk_fma_f32 v[208:209], v[192:193], s[56:57], v[44:45] op_sel_hi:[1,1,0] neg_lo:[1,0,0] neg_hi:[1,0,0]
    v_pk_fma_f32 v[172:173], v[172:173], s[56:57], v[34:35] op_sel_hi:[1,1,0]
    v_pk_fma_f32 v[192:193], v[192:193], s[56:57], v[42:43] op_sel_hi:[1,1,0]
    v_pk_fma_f32 v[190:191], v[174:175], s[56:57], v[36:37] op_sel_hi:[1,1,0] neg_lo:[1,0,0] neg_hi:[1,0,0]
    v_pk_fma_f32 v[210:211], v[194:195], s[56:57], v[44:45] op_sel_hi:[1,1,0] neg_lo:[1,0,0] neg_hi:[1,0,0]
    v_pk_fma_f32 v[174:175], v[174:175], s[56:57], v[34:35] op_sel_hi:[1,1,0]
    v_pk_fma_f32 v[194:195], v[194:195], s[56:57], v[42:43] op_sel_hi:[1,1,0]
    v_exp_f32 v160, v160
    v_pk_fma_f32 v[212:213], v[196:197], s[56:57], v[44:45] op_sel_hi:[1,1,0] neg_lo:[1,0,0] neg_hi:[1,0,0]
    v_exp_f32 v176, v176
    v_pk_fma_f32 v[196:197], v[196:197], s[56:57], v[42:43] op_sel_hi:[1,1,0]
    v_exp_f32 v161, v161
    v_pk_fma_f32 v[214:215], v[198:199], s[56:57], v[44:45] op_sel_hi:[1,1,0] neg_lo:[1,0,0] neg_hi:[1,0,0]
    v_exp_f32 v177, v177
    v_pk_fma_f32 v[198:199], v[198:199], s[56:57], v[42:43] op_sel_hi:[1,1,0]
    v_exp_f32 v162, v162
    v_pk_fma_f32 v[216:217], v[200:201], s[56:57], v[44:45] op_sel_hi:[1,1,0] neg_lo:[1,0,0] neg_hi:[1,0,0]
    v_exp_f32 v178, v178
    v_pk_fma_f32 v[200:201], v[200:201], s[56:57], v[42:43] op_sel_hi:[1,1,0]
    v_exp_f32 v163, v163
    v_pk_fma_f32 v[218:219], v[202:203], s[56:57], v[44:45] op_sel_hi:[1,1,0] neg_lo:[1,0,0] neg_hi:[1,0,0]
    v_exp_f32 v179, v179
    v_pk_fma_f32 v[202:203], v[202:203], s[56:57], v[42:43] op_sel_hi:[1,1,0]
    v_exp_f32 v164, v164
    v_pk_fma_f32 v[220:221], v[204:205], s[56:57], v[44:45] op_sel_hi:[1,1,0] neg_lo:[1,0,0] neg_hi:[1,0,0]
    v_exp_f32 v180, v180
    v_pk_fma_f32 v[204:205], v[204:205], s[56:57], v[42:43] op_sel_hi:[1,1,0]
    v_exp_f32 v165, v165
    v_pk_fma_f32 v[222:223], v[206:207], s[56:57], v[44:45] op_sel_hi:[1,1,0] neg_lo:[1,0,0] neg_hi:[1,0,0]
    v_exp_f32 v181, v181
    v_pk_fma_f32 v[206:207], v[206:207], s[56:57], v[42:43] op_sel_hi:[1,1,0]
    s_mov_b64 exec, 1
    ds_add_u32 v26, v5 offset:40272
    s_mov_b64 exec, -1
    s_mov_b32 s58, 0
G1_poll:
    buffer_load_dwordx2 v[16:17], v8, s[40:43], s66 offen offset:512 sc1
    s_add_u32 s58, s58, 1
    s_cmp_gt_u32 s58, 1048576
    s_cbranch_scc1 G1_pollok
    s_waitcnt vmcnt(0)
    v_cmp_ne_u64 vcc, v[16:17], v[28:29]
    s_nop 4
    s_cbranch_vccz G1_pollok
    s_sleep 1
    s_branch G1_poll
G1_pollok:
    s_waitcnt vmcnt(0)
    buffer_load_dword v80, v2, s[40:43], s87 offen sc1
    buffer_load_dword v64, v58, s[40:43], s86 offen sc1
    s_add_u32 s86, s86, 16384
    buffer_load_dword v65, v58, s[40:43], s86 offen sc1
    s_add_u32 s86, s86, 16384
    buffer_load_dword v66, v58, s[40:43], s86 offen sc1
    s_add_u32 s86, s86, 16384
    buffer_load_dword v67, v58, s[40:43], s86 offen sc1
    s_add_u32 s86, s86, 16384
    buffer_load_dword v68, v58, s[40:43], s86 offen sc1
    s_add_u32 s86, s86, 16384
    buffer_load_dword v69, v58, s[40:43], s86 offen sc1
    s_add_u32 s86, s86, 16384
    buffer_load_dword v70, v58, s[40:43], s86 offen sc1
    s_add_u32 s86, s86, 16384
    buffer_load_dword v71, v58, s[40:43], s86 offen sc1
    v_exp_f32 v166, v166
    v_exp_f32 v192, v192
    v_exp_f32 v182, v182
    v_exp_f32 v208, v208
    v_exp_f32 v167, v167
    v_exp_f32 v193, v193
    v_exp_f32 v183, v183
    v_exp_f32 v209, v209
    v_exp_f32 v168, v168
    v_exp_f32 v194, v194
    v_exp_f32 v184, v184
    v_exp_f32 v210, v210
    v_exp_f32 v169, v169
    v_exp_f32 v195, v195
    v_exp_f32 v185, v185
    v_exp_f32 v211, v211
    v_exp_f32 v170, v170
    v_exp_f32 v186, v186
    v_exp_f32 v171, v171
    v_exp_f32 v187, v187
    v_exp_f32 v172, v172
    v_exp_f32 v188, v188
    v_exp_f32 v173, v173
    v_exp_f32 v189, v189
    s_waitcnt vmcnt(0)
    v_and_b32 v72, 0xffff0000, v64
    v_add_f32_dpp v80, v80, v80 row_ror:8 row_mask:0xf bank_mask:0xf
    v_lshlrev_b32 v64, 16, v64
    v_and_b32 v73, 0xffff0000, v65
    v_lshlrev_b32 v65, 16, v65
    v_and_b32 v74, 0xffff0000, v66
    v_add_f32_dpp v80, v80, v80 row_ror:4 row_mask:0xf bank_mask:0xf
    v_lshlrev_b32 v66, 16, v66
    v_and_b32 v75, 0xffff0000, v67
    v_lshlrev_b32 v67, 16, v67
    v_and_b32 v76, 0xffff0000, v68
    v_add_f32_dpp v80, v80, v80 row_ror:2 row_mask:0xf bank_mask:0xf
    v_lshlrev_b32 v68, 16, v68
    v_and_b32 v77, 0xffff0000, v69
    v_lshlrev_b32 v69, 16, v69
    v_and_b32 v78, 0xffff0000, v70
    v_add_f32_dpp v80, v80, v80 row_ror:1 row_mask:0xf bank_mask:0xf
    v_lshlrev_b32 v70, 16, v70
    v_and_b32 v79, 0xffff0000, v71
    v_lshlrev_b32 v71, 16, v71
    v_add_f32 v64, v64, v68
    v_add_f32 v72, v72, v76
    v_mov_b32 v81, v80
    v_add_f32 v65, v65, v69
    v_add_f32 v73, v73, v77
    v_add_f32 v66, v66, v70
    v_add_f32 v74, v74, v78
    v_permlane16_swap_b32 v80, v81
    v_add_f32 v67, v67, v71
    v_add_f32 v75, v75, v79
    v_add_f32 v64, v64, v66
    v_add_f32 v72, v72, v74
    v_cvt_pk_bf16_f32 v82, v80, v81
    v_add_f32 v65, v65, v67
    v_add_f32 v73, v73, v75
    v_add_f32 v64, v64, v65
    v_add_f32 v72, v72, v73
    s_nop 1
    v_permlane32_swap_b32 v64, v72
    v_add_f32 v64, v64, v72
    v_mov_b32 v72, v64
    s_nop 1
    v_permlane32_swap_b32 v64, v72
    s_mov_b32 exec_hi, 0
    v_cvt_pk_bf16_f32 v82, v64, v72
    s_mov_b32 exec_hi, 1
    s_cmp_eq_u32 s49, 0
    s_cbranch_scc1 X13_slow
    buffer_store_dword v82, v3, s[40:43], 0 offen
X13_back:
    s_mov_b32 exec_hi, -1
    v_exp_f32 v174, v174
    v_exp_f32 v190, v190
    v_exp_f32 v175, v175
    v_exp_f32 v191, v191
    v_cvt_pk_bf16_f32 v224, v160, v161
    v_cvt_pk_bf16_f32 v232, v176, v177
    v_cvt_pk_bf16_f32 v225, v162, v163
    v_cvt_pk_bf16_f32 v233, v178, v179
    v_cvt_pk_bf16_f32 v226, v164, v165
    v_cvt_pk_bf16_f32 v234, v180, v181
    s_waitcnt vmcnt(0)
    s_mov_b64 exec, 1
    s_cmp_eq_u32 s49, 0
    s_cbranch_scc1 X14_slow
    buffer_store_dwordx2 v[28:29], v26, s[40:43], s67 offen offset:1024
X14_back:
    s_mov_b64 exec, -1
    v_and_b32 v14, 31, v1
    v_lshlrev_b32 v14, 3, v14
    v_cvt_pk_bf16_f32 v227, v166, v167
    v_cvt_pk_bf16_f32 v235, v182, v183
    v_cvt_pk_bf16_f32 v228, v168, v169
    v_cvt_pk_bf16_f32 v236, v184, v185
    v_cvt_pk_bf16_f32 v229, v170, v171
    v_cvt_pk_bf16_f32 v237, v186, v187
    v_cvt_pk_bf16_f32 v230, v172, v173
    v_cvt_pk_bf16_f32 v238, v188, v189
    v_cvt_pk_bf16_f32 v231, v174, v175
    v_cvt_pk_bf16_f32 v239, v190, v191
    v_mov_b32 v149, v60
    v_mov_b32 v150, v60
    v_mov_b32 v151, v60
    v_mov_b32 v152, v60
    v_mov_b32 v153, v60
    v_mov_b32 v154, v60
    v_mov_b32 v155, v60
    v_mov_b32 v156, v60
    v_mov_b32 v157, v60
    v_mov_b32 v158, v60
    v_mov_b32 v159, v60
    s_mov_b32 s60, 0x22221111
    s_mov_b32 s61, 0x22221111
    s_mov_b32 s62, 0xffff0000
    s_mov_b32 s63, 0xffff0000
    s_mov_b32 s58, 0
G2_poll:
    buffer_load_dwordx2 v[16:17], v14, s[40:43], s64 offen offset:1024 sc1
    s_add_u32 s58, s58, 1
    s_cmp_gt_u32 s58, 1048576
    s_cbranch_scc1 G2_pollok
    s_waitcnt vmcnt(0)
    v_cmp_ne_u64 vcc, v[16:17], v[28:29]
    s_nop 4
    s_cbranch_vccz G2_pollok
    s_sleep 1
    s_branch G2_poll
G2_pollok:
    s_waitcnt vmcnt(0)
    s_mov_b64 exec, s[60:61]
    buffer_load_dwordx4 v[144:147], v6, s[40:43], s88 offen offset:0 sc1
    buffer_load_dwordx4 v[148:151], v6, s[40:43], s88 offen offset:32 sc1
    buffer_load_dwordx4 v[152:155], v6, s[40:43], s88 offen offset:64 sc1
    buffer_load_dwordx4 v[156:159], v6, s[40:43], s88 offen offset:96 sc1
    s_mov_b64 exec, -1
    buffer_load_dwordx4 v[128:131], v30, s[40:43], s89 offen offset:0 sc1
    buffer_load_dwordx4 v[132:135], v30, s[40:43], s89 offen offset:1024 sc1
    buffer_load_dwordx4 v[136:139], v30, s[40:43], s89 offen offset:2048 sc1
    buffer_load_dwordx4 v[140:143], v30, s[40:43], s89 offen offset:3072 sc1
    v_exp_f32 v196, v196
    v_exp_f32 v212, v212
    v_exp_f32 v197, v197
    v_exp_f32 v213, v213
    v_exp_f32 v198, v198
    v_exp_f32 v214, v214
    v_exp_f32 v199, v199
    v_exp_f32 v215, v215
    v_exp_f32 v200, v200
    v_exp_f32 v216, v216
    v_exp_f32 v201, v201
    v_exp_f32 v217, v217
    v_exp_f32 v202, v202
    v_exp_f32 v218, v218
    v_exp_f32 v203, v203
    v_exp_f32 v219, v219
    v_exp_f32 v204, v204
    v_exp_f32 v220, v220
    v_exp_f32 v205, v205
    v_exp_f32 v221, v221
    v_exp_f32 v206, v206
    v_exp_f32 v222, v222
    v_exp_f32 v207, v207
    v_exp_f32 v223, v223
    v_cvt_pk_bf16_f32 v240, v192, v193
    v_cvt_pk_bf16_f32 v248, v208, v209
    v_cvt_pk_bf16_f32 v241, v194, v195
    v_cvt_pk_bf16_f32 v249, v210, v211
    v_cvt_pk_bf16_f32 v242, v196, v197
    v_cvt_pk_bf16_f32 v250, v212, v213
    s_waitcnt vmcnt(4)
    v_mfma_f32_16x16x32_bf16 v[160:163], v[144:147], v[224:227], 0
    v_cvt_pk_bf16_f32 v243, v198, v199
    v_cvt_pk_bf16_f32 v251, v214, v215
    v_mfma_f32_16x16x32_bf16 v[176:179], v[152:155], v[232:235], 0
    v_cvt_pk_bf16_f32 v244, v200, v201
    v_mfma_f32_16x16x32_bf16 v[160:163], v[148:151], v[228:231], v[160:163]
    v_cvt_pk_bf16_f32 v252, v216, v217
    v_mfma_f32_16x16x32_bf16 v[176:179], v[156:159], v[236:239], v[176:179]
    v_cvt_pk_bf16_f32 v245, v202, v203
    s_waitcnt vmcnt(3)
    v_mfma_f32_32x32x16_bf16 v[64:79], v[128:131], v[224:227], 0
    v_cvt_pk_bf16_f32 v253, v218, v219
    v_cvt_pk_bf16_f32 v246, v204, v205
    s_waitcnt vmcnt(2)
    v_mfma_f32_32x32x16_bf16 v[64:79], v[132:135], v[228:231], v[64:79]
    v_cvt_pk_bf16_f32 v254, v220, v221
    s_waitcnt vmcnt(1)
    v_mfma_f32_32x32x16_bf16 v[80:95], v[136:139], v[232:235], 0
    v_cvt_pk_bf16_f32 v247, v206, v207
    s_waitcnt vmcnt(0)
    v_mfma_f32_32x32x16_bf16 v[80:95], v[140:143], v[236:239], v[80:95]
    v_cvt_pk_bf16_f32 v255, v222, v223
    v_mfma_f32_16x16x32_bf16 v[192:195], v[144:147], v[240:243], 0
    v_cndmask_b32 v164, v162, v163, s[62:63]
    v_cndmask_b32 v180, v178, v179, s[62:63]
    v_cndmask_b32 v160, v160, v161, s[62:63]
    v_cndmask_b32 v176, v176, v177, s[62:63]
    v_mfma_f32_16x16x32_bf16 v[208:211], v[152:155], v[248:251], 0
    v_rcp_f32 v34, v164
    v_rcp_f32 v35, v180
    v_mov_b32 v36, 0x358637bd
    v_mfma_f32_16x16x32_bf16 v[192:195], v[148:151], v[244:247], v[192:195]
    v_fma_f32 v36, v160, v34, v36
    v_fma_f32 v36, v176, v35, v36
    v_rcp_f32 v36, v36
    v_mfma_f32_16x16x32_bf16 v[208:211], v[156:159], v[252:255], v[208:211]
    s_nop 0
    v_mul_f32 v34, v34, v36
    v_mul_f32 v35, v35, v36
    v_mfma_f32_32x32x16_bf16 v[96:111], v[128:131], v[240:243], 0
    v_mul_f32 v64, v64, v34
    v_mul_f32 v65, v65, v34
    v_mul_f32 v66, v66, v34
    v_mul_f32 v67, v67, v34
    v_mul_f32 v68, v68, v34
    v_mul_f32 v69, v69, v34
    v_mfma_f32_32x32x16_bf16 v[96:111], v[132:135], v[244:247], v[96:111]
    v_mul_f32 v70, v70, v34
    v_mul_f32 v71, v71, v34
    v_fmac_f32 v64, v80, v35
    v_fmac_f32 v65, v81, v35
    v_fmac_f32 v66, v82, v35
    v_mfma_f32_32x32x16_bf16 v[112:127], v[136:139], v[248:251], 0
    v_fmac_f32 v67, v83, v35
    v_fmac_f32 v68, v84, v35
    v_fmac_f32 v69, v85, v35
    v_fmac_f32 v70, v86, v35
    v_fmac_f32 v71, v87, v35
    v_mfma_f32_32x32x16_bf16 v[112:127], v[140:143], v[252:255], v[112:127]
    v_cvt_pk_bf16_f32 v168, v64, v65
    v_cvt_pk_bf16_f32 v169, v66, v67
    v_cvt_pk_bf16_f32 v170, v68, v69
    v_cvt_pk_bf16_f32 v171, v70, v71
    buffer_store_dwordx4 v[168:171], v59, s[40:43], s90 offen offset:0 sc1
    v_mul_f32 v72, v72, v34
    v_cndmask_b32 v196, v194, v195, s[62:63]
    v_mul_f32 v73, v73, v34
    v_cndmask_b32 v212, v210, v211, s[62:63]
    v_mul_f32 v74, v74, v34
    v_mul_f32 v75, v75, v34
    v_cndmask_b32 v192, v192, v193, s[62:63]
    v_mul_f32 v76, v76, v34
    v_cndmask_b32 v208, v208, v209, s[62:63]
    v_mul_f32 v77, v77, v34
    v_mul_f32 v78, v78, v34
    v_rcp_f32 v38, v196
    v_mul_f32 v79, v79, v34
    v_fmac_f32 v72, v88, v35
    v_rcp_f32 v39, v212
    v_fmac_f32 v73, v89, v35
    v_mov_b32 v40, 0x358637bd
    v_fmac_f32 v74, v90, v35
    v_fmac_f32 v75, v91, v35
    v_fma_f32 v40, v192, v38, v40
    v_fmac_f32 v76, v92, v35
    v_fma_f32 v40, v208, v39, v40
    v_fmac_f32 v77, v93, v35
    v_fmac_f32 v78, v94, v35
    v_rcp_f32 v40, v40
    v_fmac_f32 v79, v95, v35
    v_cvt_pk_bf16_f32 v172, v72, v73
    s_nop 0
    v_cvt_pk_bf16_f32 v173, v74, v75
    v_mul_f32 v38, v38, v40
    v_cvt_pk_bf16_f32 v174, v76, v77
    v_cvt_pk_bf16_f32 v175, v78, v79
    v_mul_f32 v39, v39, v40
    buffer_store_dwordx4 v[172:175], v59, s[40:43], s90 offen offset:512 sc1
    v_mul_f32 v96, v96, v38
    v_mul_f32 v97, v97, v38
    v_mul_f32 v98, v98, v38
    v_mul_f32 v99, v99, v38
    v_mul_f32 v100, v100, v38
    v_mul_f32 v101, v101, v38
    v_mul_f32 v102, v102, v38
    v_mul_f32 v103, v103, v38
    v_fmac_f32 v96, v112, v39
    v_fmac_f32 v97, v113, v39
    v_fmac_f32 v98, v114, v39
    v_fmac_f32 v99, v115, v39
    v_fmac_f32 v100, v116, v39
    v_fmac_f32 v101, v117, v39
    v_fmac_f32 v102, v118, v39
    v_fmac_f32 v103, v119, v39
    v_cvt_pk_bf16_f32 v200, v96, v97
    v_cvt_pk_bf16_f32 v201, v98, v99
    v_cvt_pk_bf16_f32 v202, v100, v101
    v_cvt_pk_bf16_f32 v203, v102, v103
    buffer_store_dwordx4 v[200:203], v59, s[40:43], s91 offen offset:0 sc1
    v_mul_f32 v104, v104, v38
    v_mul_f32 v105, v105, v38
    v_mul_f32 v106, v106, v38
    v_mul_f32 v107, v107, v38
    v_mul_f32 v108, v108, v38
    v_mul_f32 v109, v109, v38
    v_mul_f32 v110, v110, v38
    v_mul_f32 v111, v111, v38
    v_fmac_f32 v104, v120, v39
    v_fmac_f32 v105, v121, v39
    v_fmac_f32 v106, v122, v39
    v_fmac_f32 v107, v123, v39
    v_fmac_f32 v108, v124, v39
    v_fmac_f32 v109, v125, v39
    v_fmac_f32 v110, v126, v39
    v_fmac_f32 v111, v127, v39
    v_cvt_pk_bf16_f32 v204, v104, v105
    v_cvt_pk_bf16_f32 v205, v106, v107
    v_cvt_pk_bf16_f32 v206, v108, v109
    v_cvt_pk_bf16_f32 v207, v110, v111
    buffer_store_dwordx4 v[204:207], v59, s[40:43], s91 offen offset:512 sc1
    s_mov_b64 exec, 1
    ds_add_u32 v26, v5 offset:40244
    s_mov_b64 exec, -1
    v_lshrrev_b32 v16, 5, v1
    v_bfe_u32 v17, v1, 4, 1
    v_bfe_u32 v33, v1, 2, 2
    v_lshl_add_u32 v17, v17, 2, v33
    v_lshrrev_b32 v33, 1, v17
    v_lshl_add_u32 v17, v16, 4, v17
    v_lshlrev_b32 v17, 7, v17
    v_lshl_add_u32 v17, v33, 5, v17
    v_and_b32 v33, 3, v1
    v_lshl_add_u32 v34, v33, 3, v17
    v_xor_b32 v35, 32, v34
    v_xor_b32 v36, 64, v34
    v_xor_b32 v37, 96, v34
    v_add_u32 v38, 40960, v34
    v_add_u32 v39, 40960, v35
    v_add_u32 v40, 40960, v36
    v_add_u32 v41, 40960, v37
    v_add_u32 v42, 73728, v34
    v_add_u32 v43, 73728, v35
    v_add_u32 v44, 73728, v36
    v_add_u32 v45, 73728, v37
    v_and_b32 v14, 15, v1
    v_lshrrev_b32 v9, 5, v1
    v_and_b32 v10, 7, v1
    v_xor_b32 v10, v9, v10
    v_lshlrev_b32 v10, 4, v10
    v_bfe_u32 v9, v1, 4, 1
    v_lshl_add_u32 v10, v9, 3, v10
    v_lshl_add_u32 v10, v14, 7, v10
    s_lshl_b32 s32, s28, 12
    s_add_u32 s32, s32, 40960
    v_add_u32 v10, s32, v10
    v_lshrrev_b32 v14, 3, v1
    v_and_b32 v9, 7, v1
    v_xor_b32 v11, v14, v9
    v_lshlrev_b32 v11, 4, v11
    v_lshl_add_u32 v11, v14, 7, v11
    v_add_u32 v11, s32, v11
    v_lshlrev_b32 v9, 4, v9
    v_lshl_add_u32 v12, v14, 12, v9
    s_mov_b32 s68, 0
    s_mov_b32 s69, 0
    v_mov_b32 v46, 40212
    s_waitcnt vmcnt(0)
    s_mov_b64 exec, 1
    ds_add_rtn_u32 v16, v26, v5 offset:40228
    s_waitcnt lgkmcnt(0)
    v_readfirstlane_b32 s74, v16
    s_nop 0
    s_cmp_eq_u32 s74, 3
    s_cbranch_scc0 G3_arr
    buffer_store_dwordx2 v[28:29], v26, s[40:43], s92 offen sc1
G3_arr:
    s_mov_b64 exec, -1
    s_mov_b32 s58, 0
GK_lw:
    ds_read_b32 v16, v26 offset:40276
    s_add_u32 s58, s58, 1
    s_cmp_gt_u32 s58, 4194304
    s_cbranch_scc1 GK_lwok
    s_waitcnt lgkmcnt(0)
    v_cmp_gt_u32 vcc, 4, v16
    s_nop 0
    s_cbranch_vccz GK_lwok
    s_sleep 1
    s_branch GK_lw
GK_lwok:
    s_waitcnt lgkmcnt(0)
    s_add_u32 s32, s28, 0
    s_lshl_b32 s33, s32, 12
    s_add_u32 m0, s33, 40960
    s_xor_b32 s32, s32, s72
    s_lshl_b32 s32, s32, 16
    buffer_load_dwordx4 v32, s[44:47], s32 offen offset:0 lds
    s_add_u32 s32, s32, 15360
    buffer_load_dwordx4 v32, s[44:47], s32 offen offset:1024 lds
    s_add_u32 s32, s32, 15360
    buffer_load_dwordx4 v32, s[44:47], s32 offen offset:2048 lds
    s_add_u32 s32, s32, 15360
    buffer_load_dwordx4 v32, s[44:47], s32 offen offset:3072 lds
    s_add_u32 s32, s28, 4
    s_lshl_b32 s33, s32, 12
    s_add_u32 m0, s33, 40960
    s_xor_b32 s32, s32, s72
    s_lshl_b32 s32, s32, 16
    buffer_load_dwordx4 v32, s[44:47], s32 offen offset:0 lds
    s_add_u32 s32, s32, 15360
    buffer_load_dwordx4 v32, s[44:47], s32 offen offset:1024 lds
    s_add_u32 s32, s32, 15360
    buffer_load_dwordx4 v32, s[44:47], s32 offen offset:2048 lds
    s_add_u32 s32, s32, 15360
    buffer_load_dwordx4 v32, s[44:47], s32 offen offset:3072 lds
    s_add_u32 s32, s28, 8
    s_lshl_b32 s33, s32, 12
    s_add_u32 m0, s33, 40960
    s_xor_b32 s32, s32, s72
    s_lshl_b32 s32, s32, 16
    buffer_load_dwordx4 v32, s[44:47], s32 offen offset:0 lds
    s_add_u32 s32, s32, 15360
    buffer_load_dwordx4 v32, s[44:47], s32 offen offset:1024 lds
    s_add_u32 s32, s32, 15360
    buffer_load_dwordx4 v32, s[44:47], s32 offen offset:2048 lds
    s_add_u32 s32, s32, 15360
    buffer_load_dwordx4 v32, s[44:47], s32 offen offset:3072 lds
    s_add_u32 s32, s28, 12
    s_lshl_b32 s33, s32, 12
    s_add_u32 m0, s33, 40960
    s_xor_b32 s32, s32, s72
    s_lshl_b32 s32, s32, 16
    buffer_load_dwordx4 v32, s[44:47], s32 offen offset:0 lds
    s_add_u32 s32, s32, 15360
    buffer_load_dwordx4 v32, s[44:47], s32 offen offset:1024 lds
    s_add_u32 s32, s32, 15360
    buffer_load_dwordx4 v32, s[44:47], s32 offen offset:2048 lds
    s_add_u32 s32, s32, 15360
    buffer_load_dwordx4 v32, s[44:47], s32 offen offset:3072 lds
    s_add_u32 s32, s28, 16
    s_lshl_b32 s33, s32, 12
    s_add_u32 m0, s33, 40960
    s_xor_b32 s32, s32, s72
    s_lshl_b32 s32, s32, 16
    buffer_load_dwordx4 v32, s[44:47], s32 offen offset:0 lds
    s_add_u32 s32, s32, 15360
    buffer_load_dwordx4 v32, s[44:47], s32 offen offset:1024 lds
    s_add_u32 s32, s32, 15360
    buffer_load_dwordx4 v32, s[44:47], s32 offen offset:2048 lds
    s_add_u32 s32, s32, 15360
    buffer_load_dwordx4 v32, s[44:47], s32 offen offset:3072 lds
    s_lshl_b32 s32, s72, 11
    s_add_u32 s68, s94, s32
    s_sub_u32 s69, s94, s32
    v_add_u32 v42, 90112, v34
    v_add_u32 v43, 90112, v35
    v_add_u32 v44, 90112, v36
    v_add_u32 v45, 90112, v37
    s_cmp_eq_u32 s74, 3
    s_cbranch_scc0 G3_oth
    buffer_load_dwordx2 v[16:17], v8, s[40:43], s93 offen offset:0 sc1
    s_waitcnt vmcnt(0)
    v_cmp_ne_u64 vcc, v[16:17], v[28:29]
    s_mov_b64 exec, 1
    ds_add_u32 v26, v5 offset:40236
    s_mov_b64 exec, -1
    s_cbranch_vccz G3_rel
    s_mov_b32 s58, 0
G3_poll:
    buffer_load_dwordx2 v[16:17], v8, s[40:43], s93 offen offset:0 sc1
    s_add_u32 s58, s58, 1
    s_cmp_gt_u32 s58, 1048576
    s_cbranch_scc1 G3_pollok
    s_waitcnt vmcnt(0)
    v_cmp_ne_u64 vcc, v[16:17], v[28:29]
    s_nop 4
    s_cbranch_vccz G3_pollok
    s_sleep 1
    s_branch G3_poll
G3_pollok:
    s_waitcnt vmcnt(0)
G3_rel:
    ds_write_b32 v26, v5 offset:40248
    s_branch G3_go
G3_oth:
    s_waitcnt vmcnt(0)
    s_mov_b64 exec, 1
    ds_add_u32 v26, v5 offset:40236
    s_mov_b64 exec, -1
    s_mov_b32 s58, 0
G3_lw:
    ds_read_b32 v16, v26 offset:40248
    s_add_u32 s58, s58, 1
    s_cmp_gt_u32 s58, 4194304
    s_cbranch_scc1 G3_lwok
    s_waitcnt lgkmcnt(0)
    v_cmp_gt_u32 vcc, 1, v16
    s_nop 0
    s_cbranch_vccz G3_lwok
    s_sleep 1
    s_branch G3_lw
G3_lwok:
    s_waitcnt lgkmcnt(0)
G3_go:
    s_add_u32 s32, s68, 0
    buffer_load_dwordx4 v[96:99], v30, s[40:43], s32 offen offset:0 sc1
    buffer_load_dwordx4 v[100:103], v30, s[40:43], s32 offen offset:1024 sc1
    buffer_load_dwordx4 v[104:107], v30, s[40:43], s32 offen offset:2048 sc1
    buffer_load_dwordx4 v[108:111], v30, s[40:43], s32 offen offset:3072 sc1
    s_add_u32 s32, s68, 4096
    buffer_load_dwordx4 v[112:115], v30, s[40:43], s32 offen offset:0 sc1
    buffer_load_dwordx4 v[116:119], v30, s[40:43], s32 offen offset:1024 sc1
    buffer_load_dwordx4 v[120:123], v30, s[40:43], s32 offen offset:2048 sc1
    buffer_load_dwordx4 v[124:127], v30, s[40:43], s32 offen offset:3072 sc1
    s_add_u32 s32, s69, 8192
    buffer_load_dwordx4 v[128:131], v30, s[40:43], s32 offen offset:0 sc1
    buffer_load_dwordx4 v[132:135], v30, s[40:43], s32 offen offset:1024 sc1
    buffer_load_dwordx4 v[136:139], v30, s[40:43], s32 offen offset:2048 sc1
    buffer_load_dwordx4 v[140:143], v30, s[40:43], s32 offen offset:3072 sc1
    s_mov_b32 s58, 0
GX_lw:
    ds_read_b32 v16, v26 offset:40236
    s_add_u32 s58, s58, 1
    s_cmp_gt_u32 s58, 4194304
    s_cbranch_scc1 GX_lwok
    s_waitcnt lgkmcnt(0)
    v_cmp_gt_u32 vcc, 8, v16
    s_nop 0
    s_cbranch_vccz GX_lwok
    s_branch GX_lw
GX_lwok:
    s_waitcnt lgkmcnt(0)
    ds_read_b64_tr_b16 v[160:161], v38 offset:0
    ds_read_b64_tr_b16 v[162:163], v38 offset:1024
    ds_read_b64_tr_b16 v[164:165], v39 offset:0
    ds_read_b64_tr_b16 v[166:167], v39 offset:1024
    ds_read_b64_tr_b16 v[168:169], v40 offset:0
    ds_read_b64_tr_b16 v[170:171], v40 offset:1024
    ds_read_b64_tr_b16 v[172:173], v41 offset:0
    ds_read_b64_tr_b16 v[174:175], v41 offset:1024
    ds_read_b64_tr_b16 v[176:177], v38 offset:4096
    ds_read_b64_tr_b16 v[178:179], v38 offset:5120
    ds_read_b64_tr_b16 v[180:181], v39 offset:4096
    ds_read_b64_tr_b16 v[182:183], v39 offset:5120
    ds_read_b64_tr_b16 v[184:185], v40 offset:4096
    ds_read_b64_tr_b16 v[186:187], v40 offset:5120
    s_waitcnt lgkmcnt(8)
    ds_read_b64_tr_b16 v[188:189], v41 offset:4096
    ds_read_b64_tr_b16 v[190:191], v41 offset:5120
    s_waitcnt vmcnt(10) lgkmcnt(8)
    v_mfma_f32_16x16x32_bf16 v[64:67], v[160:163], v[96:99], 0
    ds_read_b64_tr_b16 v[192:193], v38 offset:8192
    v_mfma_f32_16x16x32_bf16 v[68:71], v[160:163], v[100:103], 0
    ds_read_b64_tr_b16 v[194:195], v38 offset:9216
    s_add_u32 s32, s69, 12288
    buffer_load_dwordx4 v[144:147], v30, s[40:43], s32 offen offset:0 sc1
    v_mfma_f32_16x16x32_bf16 v[76:79], v[164:167], v[100:103], 0
    ds_read_b64_tr_b16 v[196:197], v39 offset:8192
    v_mfma_f32_16x16x32_bf16 v[72:75], v[164:167], v[96:99], 0
    ds_read_b64_tr_b16 v[198:199], v39 offset:9216
    v_mfma_f32_16x16x32_bf16 v[80:83], v[168:171], v[96:99], 0
    ds_read_b64_tr_b16 v[200:201], v40 offset:8192
    v_mfma_f32_16x16x32_bf16 v[84:87], v[168:171], v[100:103], 0
    ds_read_b64_tr_b16 v[202:203], v40 offset:9216
    buffer_load_dwordx4 v[148:151], v30, s[40:43], s32 offen offset:1024 sc1
    v_mfma_f32_16x16x32_bf16 v[92:95], v[172:175], v[100:103], 0
    s_waitcnt lgkmcnt(12)
    ds_read_b64_tr_b16 v[204:205], v41 offset:8192
    v_mfma_f32_16x16x32_bf16 v[88:91], v[172:175], v[96:99], 0
    ds_read_b64_tr_b16 v[206:207], v41 offset:9216
    s_waitcnt vmcnt(10) lgkmcnt(8)
    v_mfma_f32_16x16x32_bf16 v[64:67], v[176:179], v[104:107], v[64:67]
    ds_read_b64_tr_b16 v[208:209], v38 offset:12288
    v_mfma_f32_16x16x32_bf16 v[68:71], v[176:179], v[108:111], v[68:71]
    ds_read_b64_tr_b16 v[210:211], v38 offset:13312
    buffer_load_dwordx4 v[152:155], v30, s[40:43], s32 offen offset:2048 sc1
    v_mfma_f32_16x16x32_bf16 v[76:79], v[180:183], v[108:111], v[76:79]
    ds_read_b64_tr_b16 v[212:213], v39 offset:12288
    v_mfma_f32_16x16x32_bf16 v[72:75], v[180:183], v[104:107], v[72:75]
    ds_read_b64_tr_b16 v[214:215], v39 offset:13312
    v_mfma_f32_16x16x32_bf16 v[80:83], v[184:187], v[104:107], v[80:83]
    ds_read_b64_tr_b16 v[216:217], v40 offset:12288
    v_mfma_f32_16x16x32_bf16 v[84:87], v[184:187], v[108:111], v[84:87]
    ds_read_b64_tr_b16 v[218:219], v40 offset:13312
    buffer_load_dwordx4 v[156:159], v30, s[40:43], s32 offen offset:3072 sc1
    v_mfma_f32_16x16x32_bf16 v[92:95], v[188:191], v[108:111], v[92:95]
    s_waitcnt lgkmcnt(12)
    ds_read_b64_tr_b16 v[220:221], v41 offset:12288
    v_mfma_f32_16x16x32_bf16 v[88:91], v[188:191], v[104:107], v[88:91]
    ds_read_b64_tr_b16 v[222:223], v41 offset:13312
    s_waitcnt vmcnt(10) lgkmcnt(8)
    v_mfma_f32_16x16x32_bf16 v[64:67], v[192:195], v[112:115], v[64:67]
    ds_read_b64_tr_b16 v[160:161], v38 offset:16384
    v_mfma_f32_16x16x32_bf16 v[68:71], v[192:195], v[116:119], v[68:71]
    ds_read_b64_tr_b16 v[162:163], v38 offset:17408
    s_add_u32 s32, s69, 24576
    buffer_load_dwordx4 v[96:99], v30, s[40:43], s32 offen offset:0 sc1
    v_mfma_f32_16x16x32_bf16 v[76:79], v[196:199], v[116:119], v[76:79]
    ds_read_b64_tr_b16 v[164:165], v39 offset:16384
    v_mfma_f32_16x16x32_bf16 v[72:75], v[196:199], v[112:115], v[72:75]
    ds_read_b64_tr_b16 v[166:167], v39 offset:17408
    v_mfma_f32_16x16x32_bf16 v[80:83], v[200:203], v[112:115], v[80:83]
    ds_read_b64_tr_b16 v[168:169], v40 offset:16384
    v_mfma_f32_16x16x32_bf16 v[84:87], v[200:203], v[116:119], v[84:87]
    ds_read_b64_tr_b16 v[170:171], v40 offset:17408
    buffer_load_dwordx4 v[100:103], v30, s[40:43], s32 offen offset:1024 sc1
    v_mfma_f32_16x16x32_bf16 v[92:95], v[204:207], v[116:119], v[92:95]
    s_waitcnt lgkmcnt(12)
    ds_read_b64_tr_b16 v[172:173], v41 offset:16384
    v_mfma_f32_16x16x32_bf16 v[88:91], v[204:207], v[112:115], v[88:91]
    ds_read_b64_tr_b16 v[174:175], v41 offset:17408
    s_waitcnt vmcnt(10) lgkmcnt(8)
    v_mfma_f32_16x16x32_bf16 v[64:67], v[208:211], v[120:123], v[64:67]
    ds_read_b64_tr_b16 v[176:177], v38 offset:20480
    v_mfma_f32_16x16x32_bf16 v[68:71], v[208:211], v[124:127], v[68:71]
    ds_read_b64_tr_b16 v[178:179], v38 offset:21504
    buffer_load_dwordx4 v[104:107], v30, s[40:43], s32 offen offset:2048 sc1
    v_mfma_f32_16x16x32_bf16 v[76:79], v[212:215], v[124:127], v[76:79]
    ds_read_b64_tr_b16 v[180:181], v39 offset:20480
    v_mfma_f32_16x16x32_bf16 v[72:75], v[212:215], v[120:123], v[72:75]
    ds_read_b64_tr_b16 v[182:183], v39 offset:21504
    s_mov_b64 exec, 1
    ds_add_u32 v26, v5 offset:40212
    s_mov_b64 exec, -1
    v_mfma_f32_16x16x32_bf16 v[80:83], v[216:219], v[120:123], v[80:83]
    ds_read_b64_tr_b16 v[184:185], v40 offset:20480
    v_mfma_f32_16x16x32_bf16 v[84:87], v[216:219], v[124:127], v[84:87]
    ds_read_b64_tr_b16 v[186:187], v40 offset:21504
    buffer_load_dwordx4 v[108:111], v30, s[40:43], s32 offen offset:3072 sc1
    v_mfma_f32_16x16x32_bf16 v[92:95], v[220:223], v[124:127], v[92:95]
    s_waitcnt lgkmcnt(12)
    ds_read_b64_tr_b16 v[188:189], v41 offset:20480
    v_mfma_f32_16x16x32_bf16 v[88:91], v[220:223], v[120:123], v[88:91]
    ds_read_b64_tr_b16 v[190:191], v41 offset:21504
    s_waitcnt vmcnt(10) lgkmcnt(9)
    v_mfma_f32_16x16x32_bf16 v[64:67], v[160:163], v[128:131], v[64:67]
    ds_read_b64_tr_b16 v[192:193], v38 offset:24576
    v_mfma_f32_16x16x32_bf16 v[68:71], v[160:163], v[132:135], v[68:71]
    ds_read_b64_tr_b16 v[194:195], v38 offset:25600
    s_add_u32 s32, s69, 28672
    buffer_load_dwordx4 v[112:115], v30, s[40:43], s32 offen offset:0 sc1
    v_mfma_f32_16x16x32_bf16 v[76:79], v[164:167], v[132:135], v[76:79]
    ds_read_b64_tr_b16 v[196:197], v39 offset:24576
    v_mfma_f32_16x16x32_bf16 v[72:75], v[164:167], v[128:131], v[72:75]
    ds_read_b64_tr_b16 v[198:199], v39 offset:25600
    v_mfma_f32_16x16x32_bf16 v[80:83], v[168:171], v[128:131], v[80:83]
    ds_read_b64_tr_b16 v[200:201], v40 offset:24576
    v_mfma_f32_16x16x32_bf16 v[84:87], v[168:171], v[132:135], v[84:87]
    ds_read_b64_tr_b16 v[202:203], v40 offset:25600
    buffer_load_dwordx4 v[116:119], v30, s[40:43], s32 offen offset:1024 sc1
    v_mfma_f32_16x16x32_bf16 v[92:95], v[172:175], v[132:135], v[92:95]
    s_waitcnt lgkmcnt(12)
    ds_read_b64_tr_b16 v[204:205], v41 offset:24576
    v_mfma_f32_16x16x32_bf16 v[88:91], v[172:175], v[128:131], v[88:91]
    ds_read_b64_tr_b16 v[206:207], v41 offset:25600
    s_waitcnt vmcnt(10) lgkmcnt(8)
    v_mfma_f32_16x16x32_bf16 v[64:67], v[176:179], v[136:139], v[64:67]
    ds_read_b64_tr_b16 v[208:209], v38 offset:28672
    v_mfma_f32_16x16x32_bf16 v[68:71], v[176:179], v[140:143], v[68:71]
    ds_read_b64_tr_b16 v[210:211], v38 offset:29696
    buffer_load_dwordx4 v[120:123], v30, s[40:43], s32 offen offset:2048 sc1
    v_mfma_f32_16x16x32_bf16 v[76:79], v[180:183], v[140:143], v[76:79]
    ds_read_b64_tr_b16 v[212:213], v39 offset:28672
    v_mfma_f32_16x16x32_bf16 v[72:75], v[180:183], v[136:139], v[72:75]
    ds_read_b64_tr_b16 v[214:215], v39 offset:29696
    v_mfma_f32_16x16x32_bf16 v[80:83], v[184:187], v[136:139], v[80:83]
    ds_read_b64_tr_b16 v[216:217], v40 offset:28672
    v_mfma_f32_16x16x32_bf16 v[84:87], v[184:187], v[140:143], v[84:87]
    ds_read_b64_tr_b16 v[218:219], v40 offset:29696
    buffer_load_dwordx4 v[124:127], v30, s[40:43], s32 offen offset:3072 sc1
    v_mfma_f32_16x16x32_bf16 v[92:95], v[188:191], v[140:143], v[92:95]
    s_waitcnt lgkmcnt(12)
    ds_read_b64_tr_b16 v[220:221], v41 offset:28672
    v_mfma_f32_16x16x32_bf16 v[88:91], v[188:191], v[136:139], v[88:91]
    ds_read_b64_tr_b16 v[222:223], v41 offset:29696
    s_waitcnt vmcnt(10) lgkmcnt(8)
    v_mfma_f32_16x16x32_bf16 v[64:67], v[192:195], v[144:147], v[64:67]
    ds_read_b64_tr_b16 v[160:161], v38 offset:32768
    v_mfma_f32_16x16x32_bf16 v[68:71], v[192:195], v[148:151], v[68:71]
    ds_read_b64_tr_b16 v[162:163], v38 offset:33792
    s_add_u32 s32, s68, 16384
    buffer_load_dwordx4 v[128:131], v30, s[40:43], s32 offen offset:0 sc1
    v_mfma_f32_16x16x32_bf16 v[76:79], v[196:199], v[148:151], v[76:79]
    ds_read_b64_tr_b16 v[164:165], v39 offset:32768
    v_mfma_f32_16x16x32_bf16 v[72:75], v[196:199], v[144:147], v[72:75]
    ds_read_b64_tr_b16 v[166:167], v39 offset:33792
    v_mfma_f32_16x16x32_bf16 v[80:83], v[200:203], v[144:147], v[80:83]
    ds_read_b64_tr_b16 v[168:169], v40 offset:32768
    v_mfma_f32_16x16x32_bf16 v[84:87], v[200:203], v[148:151], v[84:87]
    ds_read_b64_tr_b16 v[170:171], v40 offset:33792
    buffer_load_dwordx4 v[132:135], v30, s[40:43], s32 offen offset:1024 sc1
    v_mfma_f32_16x16x32_bf16 v[92:95], v[204:207], v[148:151], v[92:95]
    s_waitcnt lgkmcnt(12)
    ds_read_b64_tr_b16 v[172:173], v41 offset:32768
    v_mfma_f32_16x16x32_bf16 v[88:91], v[204:207], v[144:147], v[88:91]
    ds_read_b64_tr_b16 v[174:175], v41 offset:33792
    s_waitcnt vmcnt(10) lgkmcnt(8)
    v_mfma_f32_16x16x32_bf16 v[64:67], v[208:211], v[152:155], v[64:67]
    ds_read_b64_tr_b16 v[176:177], v38 offset:36864
    v_mfma_f32_16x16x32_bf16 v[68:71], v[208:211], v[156:159], v[68:71]
    ds_read_b64_tr_b16 v[178:179], v38 offset:37888
    buffer_load_dwordx4 v[136:139], v30, s[40:43], s32 offen offset:2048 sc1
    v_mfma_f32_16x16x32_bf16 v[76:79], v[212:215], v[156:159], v[76:79]
    ds_read_b64_tr_b16 v[180:181], v39 offset:36864
    v_mfma_f32_16x16x32_bf16 v[72:75], v[212:215], v[152:155], v[72:75]
    ds_read_b64_tr_b16 v[182:183], v39 offset:37888
    v_mfma_f32_16x16x32_bf16 v[80:83], v[216:219], v[152:155], v[80:83]
    ds_read_b64_tr_b16 v[184:185], v40 offset:36864
    v_mfma_f32_16x16x32_bf16 v[84:87], v[216:219], v[156:159], v[84:87]
    ds_read_b64_tr_b16 v[186:187], v40 offset:37888
    buffer_load_dwordx4 v[140:143], v30, s[40:43], s32 offen offset:3072 sc1
    v_mfma_f32_16x16x32_bf16 v[92:95], v[220:223], v[156:159], v[92:95]
    s_waitcnt lgkmcnt(12)
    ds_read_b64_tr_b16 v[188:189], v41 offset:36864
    v_mfma_f32_16x16x32_bf16 v[88:91], v[220:223], v[152:155], v[88:91]
    ds_read_b64_tr_b16 v[190:191], v41 offset:37888
    s_waitcnt vmcnt(10) lgkmcnt(8)
    v_mfma_f32_16x16x32_bf16 v[64:67], v[160:163], v[96:99], v[64:67]
    ds_read_b64_tr_b16 v[192:193], v38 offset:40960
    v_mfma_f32_16x16x32_bf16 v[68:71], v[160:163], v[100:103], v[68:71]
    ds_read_b64_tr_b16 v[194:195], v38 offset:41984
    s_add_u32 s32, s68, 20480
    buffer_load_dwordx4 v[144:147], v30, s[40:43], s32 offen offset:0 sc1
    v_mfma_f32_16x16x32_bf16 v[76:79], v[164:167], v[100:103], v[76:79]
    ds_read_b64_tr_b16 v[196:197], v39 offset:40960
    v_mfma_f32_16x16x32_bf16 v[72:75], v[164:167], v[96:99], v[72:75]
    ds_read_b64_tr_b16 v[198:199], v39 offset:41984
    v_mfma_f32_16x16x32_bf16 v[80:83], v[168:171], v[96:99], v[80:83]
    ds_read_b64_tr_b16 v[200:201], v40 offset:40960
    v_mfma_f32_16x16x32_bf16 v[84:87], v[168:171], v[100:103], v[84:87]
    ds_read_b64_tr_b16 v[202:203], v40 offset:41984
    buffer_load_dwordx4 v[148:151], v30, s[40:43], s32 offen offset:1024 sc1
    v_mfma_f32_16x16x32_bf16 v[92:95], v[172:175], v[100:103], v[92:95]
    s_waitcnt lgkmcnt(12)
    ds_read_b64_tr_b16 v[204:205], v41 offset:40960
    v_mfma_f32_16x16x32_bf16 v[88:91], v[172:175], v[96:99], v[88:91]
    ds_read_b64_tr_b16 v[206:207], v41 offset:41984
    s_waitcnt vmcnt(10) lgkmcnt(8)
    v_mfma_f32_16x16x32_bf16 v[64:67], v[176:179], v[104:107], v[64:67]
    ds_read_b64_tr_b16 v[208:209], v38 offset:45056
    v_mfma_f32_16x16x32_bf16 v[68:71], v[176:179], v[108:111], v[68:71]
    ds_read_b64_tr_b16 v[210:211], v38 offset:46080
    buffer_load_dwordx4 v[152:155], v30, s[40:43], s32 offen offset:2048 sc1
    v_mfma_f32_16x16x32_bf16 v[76:79], v[180:183], v[108:111], v[76:79]
    ds_read_b64_tr_b16 v[212:213], v39 offset:45056
    v_mfma_f32_16x16x32_bf16 v[72:75], v[180:183], v[104:107], v[72:75]
    ds_read_b64_tr_b16 v[214:215], v39 offset:46080
    v_mfma_f32_16x16x32_bf16 v[80:83], v[184:187], v[104:107], v[80:83]
    ds_read_b64_tr_b16 v[216:217], v40 offset:45056
    v_mfma_f32_16x16x32_bf16 v[84:87], v[184:187], v[108:111], v[84:87]
    ds_read_b64_tr_b16 v[218:219], v40 offset:46080
    buffer_load_dwordx4 v[156:159], v30, s[40:43], s32 offen offset:3072 sc1
    v_mfma_f32_16x16x32_bf16 v[92:95], v[188:191], v[108:111], v[92:95]
    s_waitcnt lgkmcnt(12)
    ds_read_b64_tr_b16 v[220:221], v41 offset:45056
    v_mfma_f32_16x16x32_bf16 v[88:91], v[188:191], v[104:107], v[88:91]
    ds_read_b64_tr_b16 v[222:223], v41 offset:46080
    s_waitcnt vmcnt(10) lgkmcnt(8)
    v_mfma_f32_16x16x32_bf16 v[64:67], v[192:195], v[112:115], v[64:67]
    ds_read_b64_tr_b16 v[160:161], v42 offset:0
    v_mfma_f32_16x16x32_bf16 v[68:71], v[192:195], v[116:119], v[68:71]
    ds_read_b64_tr_b16 v[162:163], v42 offset:1024
    s_add_u32 s32, s68, 32768
    buffer_load_dwordx4 v[96:99], v30, s[40:43], s32 offen offset:0 sc1
    v_mfma_f32_16x16x32_bf16 v[76:79], v[196:199], v[116:119], v[76:79]
    ds_read_b64_tr_b16 v[164:165], v43 offset:0
    v_mfma_f32_16x16x32_bf16 v[72:75], v[196:199], v[112:115], v[72:75]
    ds_read_b64_tr_b16 v[166:167], v43 offset:1024
    v_mfma_f32_16x16x32_bf16 v[80:83], v[200:203], v[112:115], v[80:83]
    ds_read_b64_tr_b16 v[168:169], v44 offset:0
    v_mfma_f32_16x16x32_bf16 v[84:87], v[200:203], v[116:119], v[84:87]
    ds_read_b64_tr_b16 v[170:171], v44 offset:1024
    buffer_load_dwordx4 v[100:103], v30, s[40:43], s32 offen offset:1024 sc1
    v_mfma_f32_16x16x32_bf16 v[92:95], v[204:207], v[116:119], v[92:95]
    s_waitcnt lgkmcnt(12)
    ds_read_b64_tr_b16 v[172:173], v45 offset:0
    v_mfma_f32_16x16x32_bf16 v[88:91], v[204:207], v[112:115], v[88:91]
    ds_read_b64_tr_b16 v[174:175], v45 offset:1024
    s_waitcnt vmcnt(10) lgkmcnt(8)
    v_mfma_f32_16x16x32_bf16 v[64:67], v[208:211], v[120:123], v[64:67]
    ds_read_b64_tr_b16 v[176:177], v42 offset:4096
    v_mfma_f32_16x16x32_bf16 v[68:71], v[208:211], v[124:127], v[68:71]
    ds_read_b64_tr_b16 v[178:179], v42 offset:5120
    buffer_load_dwordx4 v[104:107], v30, s[40:43], s32 offen offset:2048 sc1
    v_mfma_f32_16x16x32_bf16 v[76:79], v[212:215], v[124:127], v[76:79]
    ds_read_b64_tr_b16 v[180:181], v43 offset:4096
    v_mfma_f32_16x16x32_bf16 v[72:75], v[212:215], v[120:123], v[72:75]
    ds_read_b64_tr_b16 v[182:183], v43 offset:5120
    v_mfma_f32_16x16x32_bf16 v[80:83], v[216:219], v[120:123], v[80:83]
    ds_read_b64_tr_b16 v[184:185], v44 offset:4096
    v_mfma_f32_16x16x32_bf16 v[84:87], v[216:219], v[124:127], v[84:87]
    ds_read_b64_tr_b16 v[186:187], v44 offset:5120
    buffer_load_dwordx4 v[108:111], v30, s[40:43], s32 offen offset:3072 sc1
    v_mfma_f32_16x16x32_bf16 v[92:95], v[220:223], v[124:127], v[92:95]
    s_waitcnt lgkmcnt(12)
    ds_read_b64_tr_b16 v[188:189], v45 offset:4096
    v_mfma_f32_16x16x32_bf16 v[88:91], v[220:223], v[120:123], v[88:91]
    ds_read_b64_tr_b16 v[190:191], v45 offset:5120
    s_waitcnt vmcnt(10) lgkmcnt(8)
    v_mfma_f32_16x16x32_bf16 v[64:67], v[160:163], v[128:131], v[64:67]
    ds_read_b64_tr_b16 v[192:193], v42 offset:8192
    v_mfma_f32_16x16x32_bf16 v[68:71], v[160:163], v[132:135], v[68:71]
    ds_read_b64_tr_b16 v[194:195], v42 offset:9216
    s_add_u32 s32, s68, 36864
    buffer_load_dwordx4 v[112:115], v30, s[40:43], s32 offen offset:0 sc1
    v_mfma_f32_16x16x32_bf16 v[76:79], v[164:167], v[132:135], v[76:79]
    ds_read_b64_tr_b16 v[196:197], v43 offset:8192
    v_mfma_f32_16x16x32_bf16 v[72:75], v[164:167], v[128:131], v[72:75]
    ds_read_b64_tr_b16 v[198:199], v43 offset:9216
    v_mfma_f32_16x16x32_bf16 v[80:83], v[168:171], v[128:131], v[80:83]
    ds_read_b64_tr_b16 v[200:201], v44 offset:8192
    v_mfma_f32_16x16x32_bf16 v[84:87], v[168:171], v[132:135], v[84:87]
    ds_read_b64_tr_b16 v[202:203], v44 offset:9216
    buffer_load_dwordx4 v[116:119], v30, s[40:43], s32 offen offset:1024 sc1
    v_mfma_f32_16x16x32_bf16 v[92:95], v[172:175], v[132:135], v[92:95]
    s_waitcnt lgkmcnt(12)
    ds_read_b64_tr_b16 v[204:205], v45 offset:8192
    v_mfma_f32_16x16x32_bf16 v[88:91], v[172:175], v[128:131], v[88:91]
    ds_read_b64_tr_b16 v[206:207], v45 offset:9216
    s_waitcnt vmcnt(10) lgkmcnt(8)
    v_mfma_f32_16x16x32_bf16 v[64:67], v[176:179], v[136:139], v[64:67]
    ds_read_b64_tr_b16 v[208:209], v42 offset:12288
    v_mfma_f32_16x16x32_bf16 v[68:71], v[176:179], v[140:143], v[68:71]
    ds_read_b64_tr_b16 v[210:211], v42 offset:13312
    buffer_load_dwordx4 v[120:123], v30, s[40:43], s32 offen offset:2048 sc1
    v_mfma_f32_16x16x32_bf16 v[76:79], v[180:183], v[140:143], v[76:79]
    ds_read_b64_tr_b16 v[212:213], v43 offset:12288
    v_mfma_f32_16x16x32_bf16 v[72:75], v[180:183], v[136:139], v[72:75]
    ds_read_b64_tr_b16 v[214:215], v43 offset:13312
    v_mfma_f32_16x16x32_bf16 v[80:83], v[184:187], v[136:139], v[80:83]
    ds_read_b64_tr_b16 v[216:217], v44 offset:12288
    v_mfma_f32_16x16x32_bf16 v[84:87], v[184:187], v[140:143], v[84:87]
    ds_read_b64_tr_b16 v[218:219], v44 offset:13312
    buffer_load_dwordx4 v[124:127], v30, s[40:43], s32 offen offset:3072 sc1
    v_mfma_f32_16x16x32_bf16 v[92:95], v[188:191], v[140:143], v[92:95]
    s_waitcnt lgkmcnt(12)
    ds_read_b64_tr_b16 v[220:221], v45 offset:12288
    v_mfma_f32_16x16x32_bf16 v[88:91], v[188:191], v[136:139], v[88:91]
    ds_read_b64_tr_b16 v[222:223], v45 offset:13312
    s_waitcnt vmcnt(10) lgkmcnt(8)
    v_mfma_f32_16x16x32_bf16 v[64:67], v[192:195], v[144:147], v[64:67]
    ds_read_b64_tr_b16 v[160:161], v42 offset:16384
    v_mfma_f32_16x16x32_bf16 v[68:71], v[192:195], v[148:151], v[68:71]
    ds_read_b64_tr_b16 v[162:163], v42 offset:17408
    s_add_u32 s32, s69, 40960
    buffer_load_dwordx4 v[128:131], v30, s[40:43], s32 offen offset:0 sc1
    v_mfma_f32_16x16x32_bf16 v[76:79], v[196:199], v[148:151], v[76:79]
    ds_read_b64_tr_b16 v[164:165], v43 offset:16384
    v_mfma_f32_16x16x32_bf16 v[72:75], v[196:199], v[144:147], v[72:75]
    ds_read_b64_tr_b16 v[166:167], v43 offset:17408
    v_mfma_f32_16x16x32_bf16 v[80:83], v[200:203], v[144:147], v[80:83]
    ds_read_b64_tr_b16 v[168:169], v44 offset:16384
    v_mfma_f32_16x16x32_bf16 v[84:87], v[200:203], v[148:151], v[84:87]
    ds_read_b64_tr_b16 v[170:171], v44 offset:17408
    buffer_load_dwordx4 v[132:135], v30, s[40:43], s32 offen offset:1024 sc1
    v_mfma_f32_16x16x32_bf16 v[92:95], v[204:207], v[148:151], v[92:95]
    s_waitcnt lgkmcnt(12)
    ds_read_b64_tr_b16 v[172:173], v45 offset:16384
    v_mfma_f32_16x16x32_bf16 v[88:91], v[204:207], v[144:147], v[88:91]
    ds_read_b64_tr_b16 v[174:175], v45 offset:17408
    s_waitcnt vmcnt(10) lgkmcnt(8)
    v_mfma_f32_16x16x32_bf16 v[64:67], v[208:211], v[152:155], v[64:67]
    ds_read_b64_tr_b16 v[176:177], v42 offset:20480
    v_mfma_f32_16x16x32_bf16 v[68:71], v[208:211], v[156:159], v[68:71]
    ds_read_b64_tr_b16 v[178:179], v42 offset:21504
    buffer_load_dwordx4 v[136:139], v30, s[40:43], s32 offen offset:2048 sc1
    v_mfma_f32_16x16x32_bf16 v[76:79], v[212:215], v[156:159], v[76:79]
    ds_read_b64_tr_b16 v[180:181], v43 offset:20480
    v_mfma_f32_16x16x32_bf16 v[72:75], v[212:215], v[152:155], v[72:75]
    ds_read_b64_tr_b16 v[182:183], v43 offset:21504
    v_mfma_f32_16x16x32_bf16 v[80:83], v[216:219], v[152:155], v[80:83]
    ds_read_b64_tr_b16 v[184:185], v44 offset:20480
    v_mfma_f32_16x16x32_bf16 v[84:87], v[216:219], v[156:159], v[84:87]
    ds_read_b64_tr_b16 v[186:187], v44 offset:21504
    buffer_load_dwordx4 v[140:143], v30, s[40:43], s32 offen offset:3072 sc1
    v_mfma_f32_16x16x32_bf16 v[92:95], v[220:223], v[156:159], v[92:95]
    s_waitcnt lgkmcnt(12)
    ds_read_b64_tr_b16 v[188:189], v45 offset:20480
    v_mfma_f32_16x16x32_bf16 v[88:91], v[220:223], v[152:155], v[88:91]
    ds_read_b64_tr_b16 v[190:191], v45 offset:21504
    s_waitcnt vmcnt(10) lgkmcnt(8)
    v_mfma_f32_16x16x32_bf16 v[64:67], v[160:163], v[96:99], v[64:67]
    ds_read_b64_tr_b16 v[192:193], v42 offset:24576
    v_mfma_f32_16x16x32_bf16 v[68:71], v[160:163], v[100:103], v[68:71]
    ds_read_b64_tr_b16 v[194:195], v42 offset:25600
    s_add_u32 s32, s69, 45056
    buffer_load_dwordx4 v[144:147], v30, s[40:43], s32 offen offset:0 sc1
    v_mfma_f32_16x16x32_bf16 v[76:79], v[164:167], v[100:103], v[76:79]
    ds_read_b64_tr_b16 v[196:197], v43 offset:24576
    v_mfma_f32_16x16x32_bf16 v[72:75], v[164:167], v[96:99], v[72:75]
    ds_read_b64_tr_b16 v[198:199], v43 offset:25600
    v_mfma_f32_16x16x32_bf16 v[80:83], v[168:171], v[96:99], v[80:83]
    ds_read_b64_tr_b16 v[200:201], v44 offset:24576
    v_mfma_f32_16x16x32_bf16 v[84:87], v[168:171], v[100:103], v[84:87]
    ds_read_b64_tr_b16 v[202:203], v44 offset:25600
    buffer_load_dwordx4 v[148:151], v30, s[40:43], s32 offen offset:1024 sc1
    v_mfma_f32_16x16x32_bf16 v[92:95], v[172:175], v[100:103], v[92:95]
    s_waitcnt lgkmcnt(12)
    ds_read_b64_tr_b16 v[204:205], v45 offset:24576
    v_mfma_f32_16x16x32_bf16 v[88:91], v[172:175], v[96:99], v[88:91]
    ds_read_b64_tr_b16 v[206:207], v45 offset:25600
    s_waitcnt vmcnt(10) lgkmcnt(8)
    v_mfma_f32_16x16x32_bf16 v[64:67], v[176:179], v[104:107], v[64:67]
    ds_read_b64_tr_b16 v[208:209], v42 offset:28672
    v_mfma_f32_16x16x32_bf16 v[68:71], v[176:179], v[108:111], v[68:71]
    ds_read_b64_tr_b16 v[210:211], v42 offset:29696
    buffer_load_dwordx4 v[152:155], v30, s[40:43], s32 offen offset:2048 sc1
    v_mfma_f32_16x16x32_bf16 v[76:79], v[180:183], v[108:111], v[76:79]
    ds_read_b64_tr_b16 v[212:213], v43 offset:28672
    v_mfma_f32_16x16x32_bf16 v[72:75], v[180:183], v[104:107], v[72:75]
    ds_read_b64_tr_b16 v[214:215], v43 offset:29696
    v_mfma_f32_16x16x32_bf16 v[80:83], v[184:187], v[104:107], v[80:83]
    ds_read_b64_tr_b16 v[216:217], v44 offset:28672
    v_mfma_f32_16x16x32_bf16 v[84:87], v[184:187], v[108:111], v[84:87]
    ds_read_b64_tr_b16 v[218:219], v44 offset:29696
    buffer_load_dwordx4 v[156:159], v30, s[40:43], s32 offen offset:3072 sc1
    v_mfma_f32_16x16x32_bf16 v[92:95], v[188:191], v[108:111], v[92:95]
    s_waitcnt lgkmcnt(12)
    ds_read_b64_tr_b16 v[220:221], v45 offset:28672
    v_mfma_f32_16x16x32_bf16 v[88:91], v[188:191], v[104:107], v[88:91]
    ds_read_b64_tr_b16 v[222:223], v45 offset:29696
    s_waitcnt vmcnt(10) lgkmcnt(8)
    v_mfma_f32_16x16x32_bf16 v[64:67], v[192:195], v[112:115], v[64:67]
    ds_read_b64_tr_b16 v[160:161], v42 offset:32768
    v_mfma_f32_16x16x32_bf16 v[68:71], v[192:195], v[116:119], v[68:71]
    ds_read_b64_tr_b16 v[162:163], v42 offset:33792
    s_add_u32 s32, s69, 57344
    buffer_load_dwordx4 v[96:99], v30, s[40:43], s32 offen offset:0 sc1
    v_mfma_f32_16x16x32_bf16 v[76:79], v[196:199], v[116:119], v[76:79]
    ds_read_b64_tr_b16 v[164:165], v43 offset:32768
    v_mfma_f32_16x16x32_bf16 v[72:75], v[196:199], v[112:115], v[72:75]
    ds_read_b64_tr_b16 v[166:167], v43 offset:33792
    v_mfma_f32_16x16x32_bf16 v[80:83], v[200:203], v[112:115], v[80:83]
    ds_read_b64_tr_b16 v[168:169], v44 offset:32768
    v_mfma_f32_16x16x32_bf16 v[84:87], v[200:203], v[116:119], v[84:87]
    ds_read_b64_tr_b16 v[170:171], v44 offset:33792
    buffer_load_dwordx4 v[100:103], v30, s[40:43], s32 offen offset:1024 sc1
    v_mfma_f32_16x16x32_bf16 v[92:95], v[204:207], v[116:119], v[92:95]
    s_waitcnt lgkmcnt(12)
    ds_read_b64_tr_b16 v[172:173], v45 offset:32768
    v_mfma_f32_16x16x32_bf16 v[88:91], v[204:207], v[112:115], v[88:91]
    ds_read_b64_tr_b16 v[174:175], v45 offset:33792
    s_waitcnt vmcnt(10) lgkmcnt(8)
    v_mfma_f32_16x16x32_bf16 v[64:67], v[208:211], v[120:123], v[64:67]
    ds_read_b64_tr_b16 v[176:177], v42 offset:36864
    v_mfma_f32_16x16x32_bf16 v[68:71], v[208:211], v[124:127], v[68:71]
    ds_read_b64_tr_b16 v[178:179], v42 offset:37888
    buffer_load_dwordx4 v[104:107], v30, s[40:43], s32 offen offset:2048 sc1
    v_mfma_f32_16x16x32_bf16 v[76:79], v[212:215], v[124:127], v[76:79]
    ds_read_b64_tr_b16 v[180:181], v43 offset:36864
    v_mfma_f32_16x16x32_bf16 v[72:75], v[212:215], v[120:123], v[72:75]
    ds_read_b64_tr_b16 v[182:183], v43 offset:37888
    v_mfma_f32_16x16x32_bf16 v[80:83], v[216:219], v[120:123], v[80:83]
    ds_read_b64_tr_b16 v[184:185], v44 offset:36864
    v_mfma_f32_16x16x32_bf16 v[84:87], v[216:219], v[124:127], v[84:87]
    ds_read_b64_tr_b16 v[186:187], v44 offset:37888
    buffer_load_dwordx4 v[108:111], v30, s[40:43], s32 offen offset:3072 sc1
    v_mfma_f32_16x16x32_bf16 v[92:95], v[220:223], v[124:127], v[92:95]
    s_waitcnt lgkmcnt(12)
    ds_read_b64_tr_b16 v[188:189], v45 offset:36864
    v_mfma_f32_16x16x32_bf16 v[88:91], v[220:223], v[120:123], v[88:91]
    ds_read_b64_tr_b16 v[190:191], v45 offset:37888
    s_waitcnt vmcnt(10) lgkmcnt(8)
    v_mfma_f32_16x16x32_bf16 v[64:67], v[160:163], v[128:131], v[64:67]
    ds_read_b64_tr_b16 v[192:193], v42 offset:40960
    v_mfma_f32_16x16x32_bf16 v[68:71], v[160:163], v[132:135], v[68:71]
    ds_read_b64_tr_b16 v[194:195], v42 offset:41984
    s_add_u32 s32, s69, 61440
    buffer_load_dwordx4 v[112:115], v30, s[40:43], s32 offen offset:0 sc1
    v_mfma_f32_16x16x32_bf16 v[76:79], v[164:167], v[132:135], v[76:79]
    ds_read_b64_tr_b16 v[196:197], v43 offset:40960
    v_mfma_f32_16x16x32_bf16 v[72:75], v[164:167], v[128:131], v[72:75]
    ds_read_b64_tr_b16 v[198:199], v43 offset:41984
    v_mfma_f32_16x16x32_bf16 v[80:83], v[168:171], v[128:131], v[80:83]
    ds_read_b64_tr_b16 v[200:201], v44 offset:40960
    v_mfma_f32_16x16x32_bf16 v[84:87], v[168:171], v[132:135], v[84:87]
    ds_read_b64_tr_b16 v[202:203], v44 offset:41984
    buffer_load_dwordx4 v[116:119], v30, s[40:43], s32 offen offset:1024 sc1
    v_mfma_f32_16x16x32_bf16 v[92:95], v[172:175], v[132:135], v[92:95]
    s_waitcnt lgkmcnt(12)
    ds_read_b64_tr_b16 v[204:205], v45 offset:40960
    v_mfma_f32_16x16x32_bf16 v[88:91], v[172:175], v[128:131], v[88:91]
    ds_read_b64_tr_b16 v[206:207], v45 offset:41984
    s_waitcnt vmcnt(10) lgkmcnt(8)
    v_mfma_f32_16x16x32_bf16 v[64:67], v[176:179], v[136:139], v[64:67]
    ds_read_b32 v16, v26 offset:40260
    ds_read_b64_tr_b16 v[208:209], v42 offset:45056
    v_mfma_f32_16x16x32_bf16 v[68:71], v[176:179], v[140:143], v[68:71]
    ds_read_b64_tr_b16 v[210:211], v42 offset:46080
    buffer_load_dwordx4 v[120:123], v30, s[40:43], s32 offen offset:2048 sc1
    v_mfma_f32_16x16x32_bf16 v[76:79], v[180:183], v[140:143], v[76:79]
    ds_read_b64_tr_b16 v[212:213], v43 offset:45056
    v_mfma_f32_16x16x32_bf16 v[72:75], v[180:183], v[136:139], v[72:75]
    ds_read_b64_tr_b16 v[214:215], v43 offset:46080
    v_mfma_f32_16x16x32_bf16 v[80:83], v[184:187], v[136:139], v[80:83]
    ds_read_b64_tr_b16 v[216:217], v44 offset:45056
    v_mfma_f32_16x16x32_bf16 v[84:87], v[184:187], v[140:143], v[84:87]
    ds_read_b64_tr_b16 v[218:219], v44 offset:46080
    buffer_load_dwordx4 v[124:127], v30, s[40:43], s32 offen offset:3072 sc1
    v_mfma_f32_16x16x32_bf16 v[92:95], v[188:191], v[140:143], v[92:95]
    s_waitcnt lgkmcnt(12)
    ds_read_b64_tr_b16 v[220:221], v45 offset:45056
    v_mfma_f32_16x16x32_bf16 v[88:91], v[188:191], v[136:139], v[88:91]
    ds_read_b64_tr_b16 v[222:223], v45 offset:46080
    s_waitcnt vmcnt(10) lgkmcnt(8)
    v_cmp_gt_u32 vcc, 4, v16
    s_nop 0
    s_cbranch_vccnz GT_slow
GT_back:
    v_mfma_f32_16x16x32_bf16 v[64:67], v[192:195], v[144:147], v[64:67]
    ds_read_b64_tr_b16 v[160:161], v34 offset:0
    v_mfma_f32_16x16x32_bf16 v[68:71], v[192:195], v[148:151], v[68:71]
    ds_read_b64_tr_b16 v[162:163], v34 offset:1024
    s_add_u32 s32, s68, 49152
    buffer_load_dwordx4 v[128:131], v30, s[40:43], s32 offen offset:0 sc1
    v_mfma_f32_16x16x32_bf16 v[76:79], v[196:199], v[148:151], v[76:79]
    ds_read_b64_tr_b16 v[164:165], v35 offset:0
    v_mfma_f32_16x16x32_bf16 v[72:75], v[196:199], v[144:147], v[72:75]
    ds_read_b64_tr_b16 v[166:167], v35 offset:1024
    v_mfma_f32_16x16x32_bf16 v[80:83], v[200:203], v[144:147], v[80:83]
    ds_read_b64_tr_b16 v[168:169], v36 offset:0
    v_mfma_f32_16x16x32_bf16 v[84:87], v[200:203], v[148:151], v[84:87]
    ds_read_b64_tr_b16 v[170:171], v36 offset:1024
    buffer_load_dwordx4 v[132:135], v30, s[40:43], s32 offen offset:1024 sc1
    v_mfma_f32_16x16x32_bf16 v[92:95], v[204:207], v[148:151], v[92:95]
    s_waitcnt lgkmcnt(12)
    ds_read_b64_tr_b16 v[172:173], v37 offset:0
    v_mfma_f32_16x16x32_bf16 v[88:91], v[204:207], v[144:147], v[88:91]
    ds_read_b64_tr_b16 v[174:175], v37 offset:1024
    s_waitcnt vmcnt(10) lgkmcnt(8)
    v_mfma_f32_16x16x32_bf16 v[64:67], v[208:211], v[152:155], v[64:67]
    ds_read_b64_tr_b16 v[176:177], v34 offset:4352
    v_mfma_f32_16x16x32_bf16 v[68:71], v[208:211], v[156:159], v[68:71]
    ds_read_b64_tr_b16 v[178:179], v34 offset:5376
    buffer_load_dwordx4 v[136:139], v30, s[40:43], s32 offen offset:2048 sc1
    v_mfma_f32_16x16x32_bf16 v[76:79], v[212:215], v[156:159], v[76:79]
    ds_read_b64_tr_b16 v[180:181], v35 offset:4352
    v_mfma_f32_16x16x32_bf16 v[72:75], v[212:215], v[152:155], v[72:75]
    ds_read_b64_tr_b16 v[182:183], v35 offset:5376
    v_mfma_f32_16x16x32_bf16 v[80:83], v[216:219], v[152:155], v[80:83]
    ds_read_b64_tr_b16 v[184:185], v36 offset:4352
    v_mfma_f32_16x16x32_bf16 v[84:87], v[216:219], v[156:159], v[84:87]
    ds_read_b64_tr_b16 v[186:187], v36 offset:5376
    buffer_load_dwordx4 v[140:143], v30, s[40:43], s32 offen offset:3072 sc1
    v_mfma_f32_16x16x32_bf16 v[92:95], v[220:223], v[156:159], v[92:95]
    s_waitcnt lgkmcnt(12)
    ds_read_b64_tr_b16 v[188:189], v37 offset:4352
    v_mfma_f32_16x16x32_bf16 v[88:91], v[220:223], v[152:155], v[88:91]
    ds_read_b64_tr_b16 v[190:191], v37 offset:5376
    s_waitcnt vmcnt(10) lgkmcnt(8)
    v_mfma_f32_16x16x32_bf16 v[64:67], v[160:163], v[96:99], v[64:67]
    ds_read_b64_tr_b16 v[192:193], v34 offset:8704
    v_mfma_f32_16x16x32_bf16 v[68:71], v[160:163], v[100:103], v[68:71]
    ds_read_b64_tr_b16 v[194:195], v34 offset:9728
    s_add_u32 s32, s68, 53248
    buffer_load_dwordx4 v[144:147], v30, s[40:43], s32 offen offset:0 sc1
    v_mfma_f32_16x16x32_bf16 v[76:79], v[164:167], v[100:103], v[76:79]
    ds_read_b64_tr_b16 v[196:197], v35 offset:8704
    v_mfma_f32_16x16x32_bf16 v[72:75], v[164:167], v[96:99], v[72:75]
    ds_read_b64_tr_b16 v[198:199], v35 offset:9728
    v_mfma_f32_16x16x32_bf16 v[80:83], v[168:171], v[96:99], v[80:83]
    ds_read_b64_tr_b16 v[200:201], v36 offset:8704
    v_mfma_f32_16x16x32_bf16 v[84:87], v[168:171], v[100:103], v[84:87]
    ds_read_b64_tr_b16 v[202:203], v36 offset:9728
    buffer_load_dwordx4 v[148:151], v30, s[40:43], s32 offen offset:1024 sc1
    v_mfma_f32_16x16x32_bf16 v[92:95], v[172:175], v[100:103], v[92:95]
    s_waitcnt lgkmcnt(12)
    ds_read_b64_tr_b16 v[204:205], v37 offset:8704
    v_mfma_f32_16x16x32_bf16 v[88:91], v[172:175], v[96:99], v[88:91]
    ds_read_b64_tr_b16 v[206:207], v37 offset:9728
    s_waitcnt vmcnt(10) lgkmcnt(8)
    v_mfma_f32_16x16x32_bf16 v[64:67], v[176:179], v[104:107], v[64:67]
    ds_read_b64_tr_b16 v[208:209], v34 offset:13056
    v_mfma_f32_16x16x32_bf16 v[68:71], v[176:179], v[108:111], v[68:71]
    ds_read_b64_tr_b16 v[210:211], v34 offset:14080
    buffer_load_dwordx4 v[152:155], v30, s[40:43], s32 offen offset:2048 sc1
    v_mfma_f32_16x16x32_bf16 v[76:79], v[180:183], v[108:111], v[76:79]
    ds_read_b64_tr_b16 v[212:213], v35 offset:13056
    v_mfma_f32_16x16x32_bf16 v[72:75], v[180:183], v[104:107], v[72:75]
    ds_read_b64_tr_b16 v[214:215], v35 offset:14080
    v_mfma_f32_16x16x32_bf16 v[80:83], v[184:187], v[104:107], v[80:83]
    ds_read_b64_tr_b16 v[216:217], v36 offset:13056
    v_mfma_f32_16x16x32_bf16 v[84:87], v[184:187], v[108:111], v[84:87]
    ds_read_b64_tr_b16 v[218:219], v36 offset:14080
    buffer_load_dwordx4 v[156:159], v30, s[40:43], s32 offen offset:3072 sc1
    v_mfma_f32_16x16x32_bf16 v[92:95], v[188:191], v[108:111], v[92:95]
    s_waitcnt lgkmcnt(12)
    ds_read_b64_tr_b16 v[220:221], v37 offset:13056
    v_mfma_f32_16x16x32_bf16 v[88:91], v[188:191], v[104:107], v[88:91]
    ds_read_b64_tr_b16 v[222:223], v37 offset:14080
    s_waitcnt vmcnt(10) lgkmcnt(8)
    v_mfma_f32_16x16x32_bf16 v[64:67], v[192:195], v[112:115], v[64:67]
    ds_read_b64_tr_b16 v[160:161], v34 offset:17408
    v_mfma_f32_16x16x32_bf16 v[68:71], v[192:195], v[116:119], v[68:71]
    ds_read_b64_tr_b16 v[162:163], v34 offset:18432
    v_mfma_f32_16x16x32_bf16 v[76:79], v[196:199], v[116:119], v[76:79]
    ds_read_b64_tr_b16 v[164:165], v35 offset:17408
    v_mfma_f32_16x16x32_bf16 v[72:75], v[196:199], v[112:115], v[72:75]
    ds_read_b64_tr_b16 v[166:167], v35 offset:18432
    v_mfma_f32_16x16x32_bf16 v[80:83], v[200:203], v[112:115], v[80:83]
    ds_read_b64_tr_b16 v[168:169], v36 offset:17408
    v_mfma_f32_16x16x32_bf16 v[84:87], v[200:203], v[116:119], v[84:87]
    ds_read_b64_tr_b16 v[170:171], v36 offset:18432
    v_mfma_f32_16x16x32_bf16 v[92:95], v[204:207], v[116:119], v[92:95]
    s_waitcnt lgkmcnt(12)
    ds_read_b64_tr_b16 v[172:173], v37 offset:17408
    v_mfma_f32_16x16x32_bf16 v[88:91], v[204:207], v[112:115], v[88:91]
    ds_read_b64_tr_b16 v[174:175], v37 offset:18432
    s_waitcnt vmcnt(8) lgkmcnt(8)
    v_mfma_f32_16x16x32_bf16 v[64:67], v[208:211], v[120:123], v[64:67]
    ds_read_b64_tr_b16 v[176:177], v34 offset:21760
    v_mfma_f32_16x16x32_bf16 v[68:71], v[208:211], v[124:127], v[68:71]
    ds_read_b64_tr_b16 v[178:179], v34 offset:22784
    v_mfma_f32_16x16x32_bf16 v[76:79], v[212:215], v[124:127], v[76:79]
    ds_read_b64_tr_b16 v[180:181], v35 offset:21760
    v_mfma_f32_16x16x32_bf16 v[72:75], v[212:215], v[120:123], v[72:75]
    ds_read_b64_tr_b16 v[182:183], v35 offset:22784
    v_mfma_f32_16x16x32_bf16 v[80:83], v[216:219], v[120:123], v[80:83]
    ds_read_b64_tr_b16 v[184:185], v36 offset:21760
    v_mfma_f32_16x16x32_bf16 v[84:87], v[216:219], v[124:127], v[84:87]
    ds_read_b64_tr_b16 v[186:187], v36 offset:22784
    v_mfma_f32_16x16x32_bf16 v[92:95], v[220:223], v[124:127], v[92:95]
    s_waitcnt lgkmcnt(12)
    ds_read_b64_tr_b16 v[188:189], v37 offset:21760
    v_mfma_f32_16x16x32_bf16 v[88:91], v[220:223], v[120:123], v[88:91]
    ds_read_b64_tr_b16 v[190:191], v37 offset:22784
    s_waitcnt vmcnt(6) lgkmcnt(8)
    v_mfma_f32_16x16x32_bf16 v[64:67], v[160:163], v[128:131], v[64:67]
    ds_read_b64_tr_b16 v[192:193], v34 offset:26112
    v_mfma_f32_16x16x32_bf16 v[68:71], v[160:163], v[132:135], v[68:71]
    ds_read_b64_tr_b16 v[194:195], v34 offset:27136
    v_mfma_f32_16x16x32_bf16 v[76:79], v[164:167], v[132:135], v[76:79]
    ds_read_b64_tr_b16 v[196:197], v35 offset:26112
    v_mfma_f32_16x16x32_bf16 v[72:75], v[164:167], v[128:131], v[72:75]
    ds_read_b64_tr_b16 v[198:199], v35 offset:27136
    v_mfma_f32_16x16x32_bf16 v[80:83], v[168:171], v[128:131], v[80:83]
    ds_read_b64_tr_b16 v[200:201], v36 offset:26112
    v_mfma_f32_16x16x32_bf16 v[84:87], v[168:171], v[132:135], v[84:87]
    ds_read_b64_tr_b16 v[202:203], v36 offset:27136
    v_mfma_f32_16x16x32_bf16 v[92:95], v[172:175], v[132:135], v[92:95]
    s_waitcnt lgkmcnt(12)
    ds_read_b64_tr_b16 v[204:205], v37 offset:26112
    v_mfma_f32_16x16x32_bf16 v[88:91], v[172:175], v[128:131], v[88:91]
    ds_read_b64_tr_b16 v[206:207], v37 offset:27136
    s_waitcnt vmcnt(4) lgkmcnt(8)
    v_mfma_f32_16x16x32_bf16 v[64:67], v[176:179], v[136:139], v[64:67]
    ds_read_b32 v16, v26 offset:40212
    ds_read_b64_tr_b16 v[208:209], v34 offset:30464
    v_mfma_f32_16x16x32_bf16 v[68:71], v[176:179], v[140:143], v[68:71]
    ds_read_b64_tr_b16 v[210:211], v34 offset:31488
    v_mfma_f32_16x16x32_bf16 v[76:79], v[180:183], v[140:143], v[76:79]
    ds_read_b64_tr_b16 v[212:213], v35 offset:30464
    v_mfma_f32_16x16x32_bf16 v[72:75], v[180:183], v[136:139], v[72:75]
    ds_read_b64_tr_b16 v[214:215], v35 offset:31488
    v_mfma_f32_16x16x32_bf16 v[80:83], v[184:187], v[136:139], v[80:83]
    ds_read_b64_tr_b16 v[216:217], v36 offset:30464
    v_mfma_f32_16x16x32_bf16 v[84:87], v[184:187], v[140:143], v[84:87]
    ds_read_b64_tr_b16 v[218:219], v36 offset:31488
    v_mfma_f32_16x16x32_bf16 v[92:95], v[188:191], v[140:143], v[92:95]
    s_waitcnt lgkmcnt(12)
    ds_read_b64_tr_b16 v[220:221], v37 offset:30464
    v_mfma_f32_16x16x32_bf16 v[88:91], v[188:191], v[136:139], v[88:91]
    ds_read_b64_tr_b16 v[222:223], v37 offset:31488
    s_waitcnt vmcnt(2) lgkmcnt(8)
    v_cmp_gt_u32 vcc, 4, v16
    s_nop 0
    s_cbranch_vccnz GS_slow
GS_back:
    v_mfma_f32_16x16x32_bf16 v[64:67], v[192:195], v[144:147], v[64:67]
    v_mfma_f32_16x16x32_bf16 v[68:71], v[192:195], v[148:151], v[68:71]
    v_mfma_f32_16x16x32_bf16 v[76:79], v[196:199], v[148:151], v[76:79]
    v_mfma_f32_16x16x32_bf16 v[72:75], v[196:199], v[144:147], v[72:75]
    v_mfma_f32_16x16x32_bf16 v[80:83], v[200:203], v[144:147], v[80:83]
    v_mfma_f32_16x16x32_bf16 v[84:87], v[200:203], v[148:151], v[84:87]
    v_mfma_f32_16x16x32_bf16 v[92:95], v[204:207], v[148:151], v[92:95]
    v_mfma_f32_16x16x32_bf16 v[88:91], v[204:207], v[144:147], v[88:91]
    s_waitcnt vmcnt(0) lgkmcnt(0)
    v_mfma_f32_16x16x32_bf16 v[64:67], v[208:211], v[152:155], v[64:67]
    v_mfma_f32_16x16x32_bf16 v[68:71], v[208:211], v[156:159], v[68:71]
    v_mfma_f32_16x16x32_bf16 v[76:79], v[212:215], v[156:159], v[76:79]
    v_mfma_f32_16x16x32_bf16 v[72:75], v[212:215], v[152:155], v[72:75]
    v_mfma_f32_16x16x32_bf16 v[80:83], v[216:219], v[152:155], v[80:83]
    v_mfma_f32_16x16x32_bf16 v[84:87], v[216:219], v[156:159], v[84:87]
    v_mfma_f32_16x16x32_bf16 v[92:95], v[220:223], v[156:159], v[92:95]
    v_mfma_f32_16x16x32_bf16 v[88:91], v[220:223], v[152:155], v[88:91]
    v_xor_b32 v13, 0, v10
    v_cvt_pk_bf16_f32 v96, v64, v65
    v_cvt_pk_bf16_f32 v97, v66, v67
    ds_write_b64 v13, v[96:97] offset:0
    v_cvt_pk_bf16_f32 v98, v68, v69
    v_cvt_pk_bf16_f32 v99, v70, v71
    ds_write_b64 v13, v[98:99] offset:2048
    v_xor_b32 v13, 32, v10
    v_cvt_pk_bf16_f32 v100, v72, v73
    v_cvt_pk_bf16_f32 v101, v74, v75
    ds_write_b64 v13, v[100:101] offset:0
    v_cvt_pk_bf16_f32 v102, v76, v77
    v_cvt_pk_bf16_f32 v103, v78, v79
    ds_write_b64 v13, v[102:103] offset:2048
    v_xor_b32 v13, 64, v10
    v_cvt_pk_bf16_f32 v104, v80, v81
    v_cvt_pk_bf16_f32 v105, v82, v83
    ds_write_b64 v13, v[104:105] offset:0
    v_cvt_pk_bf16_f32 v106, v84, v85
    v_cvt_pk_bf16_f32 v107, v86, v87
    ds_write_b64 v13, v[106:107] offset:2048
    v_xor_b32 v13, 96, v10
    v_cvt_pk_bf16_f32 v108, v88, v89
    v_cvt_pk_bf16_f32 v109, v90, v91
    ds_write_b64 v13, v[108:109] offset:0
    v_cvt_pk_bf16_f32 v110, v92, v93
    v_cvt_pk_bf16_f32 v111, v94, v95
    ds_write_b64 v13, v[110:111] offset:2048
    ds_read_b128 v[128:131], v11 offset:0
    ds_read_b128 v[132:135], v11 offset:1024
    ds_read_b128 v[136:139], v11 offset:2048
    ds_read_b128 v[140:143], v11 offset:3072
    s_waitcnt lgkmcnt(3)
    buffer_store_dwordx4 v[128:131], v12, s[76:79], s95 offen nt
    s_add_u32 s95, s95, 32768
    s_waitcnt lgkmcnt(2)
    buffer_store_dwordx4 v[132:135], v12, s[76:79], s95 offen nt
    s_add_u32 s95, s95, 32768
    s_waitcnt lgkmcnt(1)
    buffer_store_dwordx4 v[136:139], v12, s[76:79], s95 offen nt
    s_add_u32 s95, s95, 32768
    s_waitcnt lgkmcnt(0)
    buffer_store_dwordx4 v[140:143], v12, s[76:79], s95 offen nt
    s_endpgm
X0_slow:
    buffer_store_dwordx4 v[16:19], v13, s[40:43], s74 offen sc1
    s_add_u32 s74, s74, 65536
    buffer_store_dwordx4 v[20:23], v13, s[40:43], s74 offen sc1
    s_add_u32 s74, s74, 65536
    buffer_store_dwordx4 v[24:27], v13, s[40:43], s74 offen sc1
    s_add_u32 s74, s74, 65536
    buffer_store_dwordx4 v[28:31], v13, s[40:43], s74 offen sc1
    s_branch X0_back
X1_slow:
    buffer_store_dwordx2 v[10:11], v9, s[40:43], s62 offen offset:128 sc1
    s_branch X1_back
SK_slow:
    s_mov_b32 s58, 0
SK_lw:
    ds_read_b32 v6, v9 offset:40244
    s_add_u32 s58, s58, 1
    s_cmp_gt_u32 s58, 4194304
    s_cbranch_scc1 SK_lwok
    s_waitcnt lgkmcnt(0)
    v_cmp_gt_u32 vcc, 4, v6
    s_nop 0
    s_cbranch_vccz SK_lwok
    s_sleep 1
    s_branch SK_lw
SK_lwok:
    s_waitcnt lgkmcnt(0)
    s_branch SK_back
X3_slow:
    buffer_store_dwordx4 v[16:19], v2, s[40:43], s88 offen sc1
    s_branch X3_back
X4_slow:
    buffer_store_dwordx4 v[20:23], v2, s[40:43], s88 offen sc1
    s_branch X4_back
X5_slow:
    buffer_store_dwordx4 v[24:27], v2, s[40:43], s88 offen sc1
    s_branch X5_back
X6_slow:
    buffer_store_dwordx4 v[28:31], v2, s[40:43], s88 offen sc1
    s_branch X6_back
X7_slow:
    buffer_store_dwordx2 v[10:11], v9, s[40:43], s62 offen offset:256 sc1
    s_branch X7_back
GE_slow:
    s_mov_b32 s58, 0
GE_lw:
    ds_read_b32 v16, v26 offset:40268
    s_add_u32 s58, s58, 1
    s_cmp_gt_u32 s58, 4194304
    s_cbranch_scc1 GE_lwok
    s_waitcnt lgkmcnt(0)
    v_cmp_gt_u32 vcc, 4, v16
    s_nop 0
    s_cbranch_vccz GE_lwok
    s_branch GE_lw
GE_lwok:
    s_waitcnt lgkmcnt(0)
    s_branch GE_back
GP_slow:
    s_mov_b32 s58, 0
GP_lw:
    ds_read_b32 v16, v4 offset:40192
    s_add_u32 s58, s58, 1
    s_cmp_gt_u32 s58, 4194304
    s_cbranch_scc1 GP_lwok
    s_waitcnt lgkmcnt(0)
    v_cmp_gt_u32 vcc, 2, v16
    s_nop 0
    s_cbranch_vccz GP_lwok
    s_branch GP_lw
GP_lwok:
    s_waitcnt lgkmcnt(0)
    s_branch GP_back
GU_slow:
    s_mov_b32 s58, 0
GU_lw:
    ds_read_b32 v16, v26 offset:40200
    s_add_u32 s58, s58, 1
    s_cmp_gt_u32 s58, 4194304
    s_cbranch_scc1 GU_lwok
    s_waitcnt lgkmcnt(0)
    v_cmp_gt_u32 vcc, 4, v16
    s_nop 0
    s_cbranch_vccz GU_lwok
    s_branch GU_lw
GU_lwok:
    s_waitcnt lgkmcnt(0)
    s_branch GU_back
X11_slow:
    buffer_store_dwordx4 v[208:211], v30, s[40:43], s82 offen offset:0 sc1
    buffer_store_dwordx4 v[212:215], v30, s[40:43], s82 offen offset:1024 sc1
    s_mov_b64 exec, 0xffff
    buffer_store_dwordx2 v[216:217], v8, s[40:43], s83 offen sc1
    s_mov_b64 exec, -1
    s_branch X11_back
X12_slow:
    buffer_store_dwordx2 v[28:29], v26, s[40:43], s67 offen offset:512 sc1
    s_branch X12_back
X13_slow:
    buffer_store_dword v82, v3, s[40:43], 0 offen sc1
    s_branch X13_back
X14_slow:
    buffer_store_dwordx2 v[28:29], v26, s[40:43], s67 offen offset:1024 sc1
    s_branch X14_back
GT_slow:
    s_mov_b32 s58, 0
GT_lw:
    ds_read_b32 v16, v26 offset:40260
    s_add_u32 s58, s58, 1
    s_cmp_gt_u32 s58, 4194304
    s_cbranch_scc1 GT_lwok
    s_waitcnt lgkmcnt(0)
    v_cmp_gt_u32 vcc, 4, v16
    s_nop 0
    s_cbranch_vccz GT_lwok
    s_sleep 1
    s_branch GT_lw
GT_lwok:
    s_waitcnt lgkmcnt(0)
    s_branch GT_back
GS_slow:
    s_mov_b32 s58, 0
GS_lw:
    ds_read_b32 v16, v26 offset:40212
    s_add_u32 s58, s58, 1
    s_cmp_gt_u32 s58, 4194304
    s_cbranch_scc1 GS_lwok
    s_waitcnt lgkmcnt(0)
    v_cmp_gt_u32 vcc, 4, v16
    s_nop 0
    s_cbranch_vccz GS_lwok
    s_sleep 1
    s_branch GS_lw
GS_lwok:
    s_waitcnt lgkmcnt(0)
    s_branch GS_back
K_end:
    s_endpgm
.section .rodata,"a"
.p2align 6
.amdhsa_kernel concat_heads__linear_kernel_hedgehog__ssm_conv_s4d__prompt_kernel
  .amdhsa_next_free_vgpr 256
  .amdhsa_next_free_sgpr 102
  .amdhsa_accum_offset 256
  .amdhsa_group_segment_fixed_size 0
  .amdhsa_kernarg_size 112
  .amdhsa_user_sgpr_count 2
  .amdhsa_user_sgpr_kernarg_segment_ptr 1
  .amdhsa_system_sgpr_workgroup_id_x 1
.end_amdhsa_kernel
```
